```python
import torch

def _softmax(x, axis=-1):
    return torch.softmax(x, dim=axis)
def _gelu(x):
    return torch.nn.functional.gelu(x, approximate="tanh")
def _silu(x):
    return torch.nn.functional.silu(x)
def _sigmoid(x):
    return torch.sigmoid(x)
def _layernorm(x, axis=-1, eps=1e-5):
    m = x.mean(dim=axis, keepdim=True)
    v = x.var(dim=axis, keepdim=True, unbiased=False)
    return (x - m) / torch.sqrt(v + eps)
def _scatter_add(tgt, idx, src, axis=0):
    return tgt.clone().index_add_(axis, idx, src)
def _segment_sum(src, seg, n):
    out = torch.zeros((n,) + src.shape[1:], dtype=src.dtype)
    return out.index_add_(0, seg, src)
def _pad(x, pw):
    flat = tuple(v for pair in reversed(pw) for v in pair)
    return torch.nn.functional.pad(x, flat)

kernel_name = 'parallel_sum__sliding_local_dilated__glu_gated_geglu__prompt'

def setup_inputs():

    _w = (lambda a: (lambda t: t.to(torch.bfloat16) if t.is_floating_point() else t)(torch.as_tensor(a)))
    def _A_setup():
        B, S, D = 1, 2048, 640
        return {
            "x": _w((lambda *s: torch.randn(*s, dtype=torch.bfloat16) * 0.05)(B, S, D)),
            "wqkv": _w((lambda *s: torch.randn(*s, dtype=torch.bfloat16) * 0.05)(D, 3 * D)),
            "wo": _w((lambda *s: torch.randn(*s, dtype=torch.bfloat16) * 0.05)(D, D)),
        }
    _A_in = _A_setup()

    def _B_setup():
        B, S, Dm, Df = 1, 2048, 640, 1536
        return {
            "x": _w((lambda *s: torch.randn(*s, dtype=torch.bfloat16) * 0.05)(B, S, Dm)),
            "w_gate": _w((lambda *s: torch.randn(*s, dtype=torch.bfloat16) * 0.8)(Dm, Df) * (Dm ** -0.5)),
            "w_up": _w((lambda *s: torch.randn(*s, dtype=torch.bfloat16) * 0.8)(Dm, Df) * (Dm ** -0.5)),
            "w_down": _w((lambda *s: torch.randn(*s, dtype=torch.bfloat16) * 0.8)(Df, Dm) * (Df ** -0.5)),
        }
    _B_in = _B_setup()

    return {
        "A_x": _A_in["x"],
        "A_wqkv": _A_in["wqkv"],
        "A_wo": _A_in["wo"],
        "B_x": _B_in["x"],
        "B_w_gate": _B_in["w_gate"],
        "B_w_up": _B_in["w_up"],
        "B_w_down": _B_in["w_down"],
    }

def reference(A_x, A_wqkv, A_wo, B_x, B_w_gate, B_w_up, B_w_down):
    def _A_ref(x, wqkv, wo):
        B, S, D = x.shape
        H = 32; Dh = D // H
        W, dil = 8, 2
        qkv = (lambda x, *d: x.permute(*d))((x @ wqkv).reshape(B, S, 3, H, Dh), 2, 0, 3, 1, 4)
        q, k, v = qkv[0], qkv[1], qkv[2]
        scale = Dh ** -0.5
        pos = torch.arange(S)
        off = torch.arange(W) * dil
        idx = pos[:, None] - off[None, :]
        mask = idx >= 0
        idx_c = torch.where(mask, idx, 0).reshape(-1)
        kg = k[:, :, idx_c, :].reshape(B, H, S, W, Dh)
        vg = v[:, :, idx_c, :].reshape(B, H, S, W, Dh)
        logits = torch.einsum("bhsd,bhswd->bhsw", q, kg) * scale
        logits = torch.where(mask[None, None, :, :], logits, -1e9)
        attn = _softmax(logits, axis=-1)
        o = torch.einsum("bhsw,bhswd->bhsd", attn, vg)
        return (lambda x, *d: x.permute(*d))(o, 0, 2, 1, 3).reshape(B, S, D) @ wo

    def _B_ref(x, w_gate, w_up, w_down):
        g = torch.einsum("bsd,df->bsf", x, w_gate)
        u = torch.einsum("bsd,df->bsf", x, w_up)
        h = _gelu(g) * u
        return torch.einsum("bsf,fd->bsd", h, w_down)

    x = A_x
    xn = _layernorm(x, axis=-1)
    return x + _A_ref(xn, A_wqkv, A_wo) + _B_ref(xn, B_w_gate, B_w_up, B_w_down)
```

```asm
; @launch grid=(256,1,1) block=(512,1,1) lds=163840
.amdgcn_target "amdgcn-amd-amdhsa--gfx950"
.text
.globl parallel_sum__sliding_local_dilated__glu_gated_geglu__prompt_kernel
.type parallel_sum__sliding_local_dilated__glu_gated_geglu__prompt_kernel,@function
.p2align 8
parallel_sum__sliding_local_dilated__glu_gated_geglu__prompt_kernel:
    s_cmp_ge_u32 s2, 256
    s_cbranch_scc1 k_exit
    s_load_dwordx4 s[4:7], s[0:1], 0
    s_load_dwordx4 s[12:15], s[0:1], 32
    s_load_dwordx4 s[20:23], s[0:1], 64
    s_load_dwordx2 s[8:9], s[0:1], 16
    s_load_dwordx4 s[16:19], s[0:1], 48
    v_lshrrev_b32 v1, 6, v0
    v_and_b32 v243, 63, v0
    v_readfirstlane_b32 s40, v1
    s_getpc_b64 s[46:47]
k_pc:
    s_cmp_ge_u32 s40, 4
    s_cbranch_scc1 k_nopf
    v_lshlrev_b32 v2, 7, v0
    v_add_u32 v3, 32768, v2
    v_min_u32 v2, k_end-k_pc-4, v2
    v_min_u32 v3, k_end-k_pc-4, v3
    v_and_b32 v2, -4, v2
    v_and_b32 v3, -4, v3
    global_load_dword v255, v2, s[46:47]
    global_load_dword v254, v3, s[46:47]
k_nopf:
    s_and_b32 s44, s2, 3
    s_bfe_u32 s48, s2, 0x10002
    s_lshr_b32 s46, s2, 3
    s_sub_u32 s49, 10, s48
    s_lshl_b32 s50, s49, 1
    s_mul_i32 s51, s48, 10
    s_cmp_ge_u32 s46, s50
    s_cselect_b32 s43, 1, 0
    s_cbranch_scc0 k_d1
    s_sub_u32 s46, s46, s50
    s_add_u32 s49, s48, 6
    s_mul_i32 s51, s48, 6
k_d1:
    s_cmp_ge_u32 s46, s49
    s_cselect_b32 s47, 1, 0
    s_cselect_b32 s50, s49, 0
    s_sub_u32 s46, s46, s50
    s_lshl_b32 s44, s44, 1
    s_add_u32 s44, s44, s47
    s_add_u32 s45, s46, s51
    s_mul_i32 s41, s45, 108
    s_mul_i32 s50, s45, 160
    s_sub_u32 s50, s50, 16
    s_cmp_eq_u32 s43, 1
    s_cselect_b32 s41, s50, s41
    s_cmp_lt_u32 s40, 4
    s_cbranch_scc1 k_cons
    s_sub_u32 s40, s40, 4
    s_cmp_eq_u32 s40, 3
    s_cbranch_scc1 k_serv
    s_mul_i32 s68, s47, 2
    s_add_u32 s68, s68, s46
    s_mul_i32 s46, s43, 1
    s_add_u32 s68, s68, s46
    s_cmp_ge_u32 s68, 5
    s_cselect_b32 s46, 5, 0
    s_sub_u32 s68, s68, s46
    s_cmp_ge_u32 s68, 5
    s_cselect_b32 s46, 5, 0
    s_sub_u32 s68, s68, s46
    s_mov_b32 s64, 1985229328
    s_mov_b32 s65, 152
    s_cmp_eq_u32 s68, 1
    s_cselect_b32 s64, 2557891634, s64
    s_cselect_b32 s65, 16, s65
    s_cmp_eq_u32 s68, 2
    s_cselect_b32 s64, 278427220, s64
    s_cselect_b32 s65, 50, s65
    s_cmp_eq_u32 s68, 3
    s_cselect_b32 s64, 839948406, s64
    s_cselect_b32 s65, 84, s65
    s_cmp_eq_u32 s68, 4
    s_cselect_b32 s64, 1412567192, s64
    s_cselect_b32 s65, 118, s65
    s_mov_b64 s[66:67], s[64:65]
    s_and_b32 s68, s64, 15
    s_mov_b32 s69, 0
    v_lshrrev_b32 v2, 3, v243
    v_and_b32 v3, 7, v243
    s_movk_i32 s53, 1280
    s_lshl_b32 s58, s68, 7
    s_lshl_b32 s54, s40, 10
    s_mov_b32 s61, 0
    v_mov_b32 v9, 2130706432
    s_cmp_eq_u32 s43, 1
    s_cbranch_scc1 k_ldq
    v_lshrrev_b32 v4, 1, v2
    v_xor_b32 v4, v4, v3
    s_and_b32 s51, s40, 1
    s_lshl_b32 s51, s51, 2
    v_xor_b32 v4, s51, v4
    v_lshlrev_b32 v4, 4, v4
    s_lshl_b32 s52, s40, 3
    s_add_u32 s52, s52, s41
    v_add_u32 v5, s52, v2
    v_mul_lo_u32 v6, v5, s53
    v_add_u32 v12, v6, v4
    v_xor_b32 v7, 64, v12
    v_add_u32 v13, 30720, v7
    v_add_u32 v14, 61440, v12
    v_add_u32 v15, 92160, v7
    v_add_u32 v16, 122880, v12
    v_subrev_u32 v5, s41, v5
    v_cmp_gt_u32 vcc, 12, v5
    s_nop 1
    v_cndmask_b32 v16, v9, v16, vcc
    s_add_u32 s59, s54, 98304
    s_waitcnt lgkmcnt(0)
    s_mov_b32 s24, s4
    s_mov_b32 s25, s5
    s_mov_b32 s26, 2621440
    s_mov_b32 s27, 0x20000
    s_add_u32 m0, s59, 0
    s_nop 0
    buffer_load_dwordx4 v12, s[24:27], s58 offen  lds
    s_add_u32 m0, s59, 3072
    s_nop 0
    buffer_load_dwordx4 v13, s[24:27], s58 offen  lds
    s_add_u32 m0, s59, 6144
    s_nop 0
    buffer_load_dwordx4 v14, s[24:27], s58 offen  lds
    s_add_u32 m0, s59, 9216
    s_nop 0
    buffer_load_dwordx4 v15, s[24:27], s58 offen  lds
    s_cmp_ge_u32 s40, 2
    s_cbranch_scc1 lg_sk1
    s_add_u32 m0, s59, 12288
    s_nop 0
    buffer_load_dwordx4 v16, s[24:27], s58 offen  lds
lg_sk1:
    s_lshr_b64 s[66:67], s[66:67], 4
    s_and_b32 s58, s66, 15
    s_lshl_b32 s58, s58, 7
    s_add_u32 s59, s59, 14336
    s_cmp_ge_u32 s59, 141312
    s_cselect_b32 s60, 43008, 0
    s_sub_u32 s59, s59, s60
    s_movk_i32 s42, 3072
    s_mov_b32 s28, s12
    s_mov_b32 s29, s13
    s_mov_b32 s30, 1966080
    s_mov_b32 s31, 0x20000
    s_mov_b32 s32, s14
    s_mov_b32 s33, s15
    s_mov_b32 s34, 1966080
    s_mov_b32 s35, 0x20000
    v_bfe_u32 v4, v243, 4, 1
    v_lshlrev_b32 v4, 2, v4
    v_xor_b32 v4, v4, v3
    v_lshlrev_b32 v4, 4, v4
    s_mul_i32 s46, s44, 384
    s_lshl_b32 s47, s40, 7
    s_add_u32 s46, s46, s47
    v_mad_u32_u24 v4, v2, s42, v4
    v_add_u32 v20, s46, v4
    v_xor_b32 v4, 16, v20
    v_add_u32 v21, 24576, v4
    v_add_u32 v22, 49152, v20
    v_add_u32 v23, 73728, v4
    s_lshl_b32 s57, s40, 12
    s_mul_i32 s56, s68, 196608
    s_add_u32 m0, s57, 0
    s_nop 0
    buffer_load_dwordx4 v20, s[28:31], s56 offen  lds
    s_add_u32 m0, s57, 1024
    s_nop 0
    buffer_load_dwordx4 v21, s[28:31], s56 offen  lds
    s_add_u32 m0, s57, 2048
    s_nop 0
    buffer_load_dwordx4 v22, s[28:31], s56 offen  lds
    s_add_u32 m0, s57, 3072
    s_nop 0
    buffer_load_dwordx4 v23, s[28:31], s56 offen  lds
    s_add_u32 m0, s57, 12288
    s_nop 0
    buffer_load_dwordx4 v20, s[32:35], s56 offen  lds
    s_add_u32 m0, s57, 13312
    s_nop 0
    buffer_load_dwordx4 v21, s[32:35], s56 offen  lds
    s_add_u32 m0, s57, 14336
    s_nop 0
    buffer_load_dwordx4 v22, s[32:35], s56 offen  lds
    s_add_u32 m0, s57, 15360
    s_nop 0
    buffer_load_dwordx4 v23, s[32:35], s56 offen  lds
    s_add_u32 s56, s56, 98304
    s_add_u32 s57, s57, 24576
    s_cmp_ge_u32 s57, 98304
    s_cselect_b32 s60, 98304, 0
    s_sub_u32 s57, s57, s60
    s_add_u32 m0, s57, 0
    s_nop 0
    buffer_load_dwordx4 v20, s[28:31], s56 offen  lds
    s_add_u32 m0, s57, 1024
    s_nop 0
    buffer_load_dwordx4 v21, s[28:31], s56 offen  lds
    s_add_u32 m0, s57, 2048
    s_nop 0
    buffer_load_dwordx4 v22, s[28:31], s56 offen  lds
    s_add_u32 m0, s57, 3072
    s_nop 0
    buffer_load_dwordx4 v23, s[28:31], s56 offen  lds
    s_add_u32 m0, s57, 12288
    s_nop 0
    buffer_load_dwordx4 v20, s[32:35], s56 offen  lds
    s_add_u32 m0, s57, 13312
    s_nop 0
    buffer_load_dwordx4 v21, s[32:35], s56 offen  lds
    s_add_u32 m0, s57, 14336
    s_nop 0
    buffer_load_dwordx4 v22, s[32:35], s56 offen  lds
    s_add_u32 m0, s57, 15360
    s_nop 0
    buffer_load_dwordx4 v23, s[32:35], s56 offen  lds
    s_lshr_b64 s[64:65], s[64:65], 4
    s_and_b32 s56, s64, 15
    s_mul_i32 s56, s56, 196608
    s_add_u32 s57, s57, 24576
    s_cmp_ge_u32 s57, 98304
    s_cselect_b32 s60, 98304, 0
    s_sub_u32 s57, s57, s60
    s_add_u32 s10, s22, 21037056
    s_addc_u32 s11, s23, 0
    s_add_u32 s36, s22, 9437184
    s_addc_u32 s37, s23, 0
    s_mov_b32 s38, 2785280
    s_mov_b32 s39, 0x20000
    v_lshlrev_b32 v248, 4, v243
    s_lshr_b32 s47, s2, 6
    s_bfe_u32 s48, s2, 0x30003
    s_mul_i32 s49, s48, 348160
    s_mul_i32 s50, s40, 87040
    s_add_u32 s49, s49, s50
    s_lshl_b32 s47, s47, 1
    s_add_u32 s48, s48, s47
    s_add_u32 s74, s48, 0
    s_and_b32 s74, s74, 7
    s_mul_i32 s74, s74, 5120
    s_add_u32 s74, s74, s49
    s_add_u32 s75, s74, 4096
    s_add_u32 s76, s48, 1
    s_and_b32 s76, s76, 7
    s_mul_i32 s76, s76, 5120
    s_add_u32 s76, s76, s49
    s_add_u32 s77, s76, 4096
    s_waitcnt vmcnt(8)
    s_barrier
    s_add_u32 m0, s57, 0
    s_nop 0
    buffer_load_dwordx4 v20, s[28:31], s56 offen  lds
    s_add_u32 m0, s57, 1024
    s_nop 0
    buffer_load_dwordx4 v21, s[28:31], s56 offen  lds
    s_add_u32 m0, s57, 2048
    s_nop 0
    buffer_load_dwordx4 v22, s[28:31], s56 offen  lds
    s_add_u32 m0, s57, 3072
    s_nop 0
    buffer_load_dwordx4 v23, s[28:31], s56 offen  lds
    s_add_u32 m0, s57, 12288
    s_nop 0
    buffer_load_dwordx4 v20, s[32:35], s56 offen  lds
    s_add_u32 m0, s57, 13312
    s_nop 0
    buffer_load_dwordx4 v21, s[32:35], s56 offen  lds
    s_add_u32 m0, s57, 14336
    s_nop 0
    buffer_load_dwordx4 v22, s[32:35], s56 offen  lds
    s_add_u32 m0, s57, 15360
    s_nop 0
    buffer_load_dwordx4 v23, s[32:35], s56 offen  lds
    s_add_u32 s56, s56, 98304
    s_add_u32 s57, s57, 24576
    s_cmp_ge_u32 s57, 98304
    s_cselect_b32 s60, 98304, 0
    s_sub_u32 s57, s57, s60
    s_waitcnt vmcnt(8)
    s_barrier
    s_add_u32 m0, s59, 0
    s_nop 0
    buffer_load_dwordx4 v12, s[24:27], s58 offen  lds
    s_add_u32 m0, s59, 3072
    s_nop 0
    buffer_load_dwordx4 v13, s[24:27], s58 offen  lds
    s_add_u32 m0, s59, 6144
    s_nop 0
    buffer_load_dwordx4 v14, s[24:27], s58 offen  lds
    s_add_u32 m0, s59, 9216
    s_nop 0
    buffer_load_dwordx4 v15, s[24:27], s58 offen  lds
    s_cmp_ge_u32 s40, 2
    s_cbranch_scc1 lg_sk2
    s_add_u32 m0, s59, 12288
    s_nop 0
    buffer_load_dwordx4 v16, s[24:27], s58 offen  lds
lg_sk2:
    s_lshr_b64 s[66:67], s[66:67], 4
    s_and_b32 s58, s66, 15
    s_lshl_b32 s58, s58, 7
    s_add_u32 s59, s59, 14336
    s_cmp_ge_u32 s59, 141312
    s_cselect_b32 s60, 43008, 0
    s_sub_u32 s59, s59, s60
    s_add_u32 m0, s57, 0
    s_nop 0
    buffer_load_dwordx4 v20, s[28:31], s56 offen  lds
    s_add_u32 m0, s57, 1024
    s_nop 0
    buffer_load_dwordx4 v21, s[28:31], s56 offen  lds
    s_add_u32 m0, s57, 2048
    s_nop 0
    buffer_load_dwordx4 v22, s[28:31], s56 offen  lds
    s_add_u32 m0, s57, 3072
    s_nop 0
    buffer_load_dwordx4 v23, s[28:31], s56 offen  lds
    s_add_u32 m0, s57, 12288
    s_nop 0
    buffer_load_dwordx4 v20, s[32:35], s56 offen  lds
    s_add_u32 m0, s57, 13312
    s_nop 0
    buffer_load_dwordx4 v21, s[32:35], s56 offen  lds
    s_add_u32 m0, s57, 14336
    s_nop 0
    buffer_load_dwordx4 v22, s[32:35], s56 offen  lds
    s_add_u32 m0, s57, 15360
    s_nop 0
    buffer_load_dwordx4 v23, s[32:35], s56 offen  lds
    s_lshr_b64 s[64:65], s[64:65], 4
    s_and_b32 s56, s64, 15
    s_mul_i32 s56, s56, 196608
    s_add_u32 s57, s57, 24576
    s_cmp_ge_u32 s57, 98304
    s_cselect_b32 s60, 98304, 0
    s_sub_u32 s57, s57, s60
lg_loop:
    s_add_u32 m0, s57, 0
    s_nop 0
    buffer_load_dwordx4 v20, s[28:31], s56 offen  lds
    s_add_u32 m0, s57, 1024
    s_nop 0
    buffer_load_dwordx4 v21, s[28:31], s56 offen  lds
    s_add_u32 m0, s57, 2048
    s_nop 0
    buffer_load_dwordx4 v22, s[28:31], s56 offen  lds
    s_add_u32 m0, s57, 3072
    s_nop 0
    buffer_load_dwordx4 v23, s[28:31], s56 offen  lds
    s_add_u32 m0, s57, 12288
    s_nop 0
    buffer_load_dwordx4 v20, s[32:35], s56 offen  lds
    s_add_u32 m0, s57, 13312
    s_nop 0
    buffer_load_dwordx4 v21, s[32:35], s56 offen  lds
    s_add_u32 m0, s57, 14336
    s_nop 0
    buffer_load_dwordx4 v22, s[32:35], s56 offen  lds
    s_add_u32 m0, s57, 15360
    s_nop 0
    buffer_load_dwordx4 v23, s[32:35], s56 offen  lds
    s_add_u32 m0, s59, 0
    s_nop 0
    buffer_load_dwordx4 v12, s[24:27], s58 offen  lds
    s_add_u32 m0, s59, 3072
    s_nop 0
    buffer_load_dwordx4 v13, s[24:27], s58 offen  lds
    s_add_u32 m0, s59, 6144
    s_nop 0
    buffer_load_dwordx4 v14, s[24:27], s58 offen  lds
    s_add_u32 s56, s56, 98304
    s_add_u32 s57, s57, 24576
    s_cmp_ge_u32 s57, 98304
    s_cselect_b32 s60, 98304, 0
    s_sub_u32 s57, s57, s60
    s_waitcnt vmcnt(19)
    s_barrier
    s_add_u32 m0, s59, 9216
    s_nop 0
    buffer_load_dwordx4 v15, s[24:27], s58 offen  lds
    s_cmp_ge_u32 s40, 2
    s_cbranch_scc1 lg_sk3
    s_add_u32 m0, s59, 12288
    s_nop 0
    buffer_load_dwordx4 v16, s[24:27], s58 offen  lds
lg_sk3:
    s_add_u32 m0, s57, 0
    s_nop 0
    buffer_load_dwordx4 v20, s[28:31], s56 offen  lds
    s_add_u32 m0, s57, 1024
    s_nop 0
    buffer_load_dwordx4 v21, s[28:31], s56 offen  lds
    s_add_u32 m0, s57, 2048
    s_nop 0
    buffer_load_dwordx4 v22, s[28:31], s56 offen  lds
    s_add_u32 m0, s57, 3072
    s_nop 0
    buffer_load_dwordx4 v23, s[28:31], s56 offen  lds
    s_add_u32 m0, s57, 12288
    s_nop 0
    buffer_load_dwordx4 v20, s[32:35], s56 offen  lds
    s_add_u32 m0, s57, 13312
    s_nop 0
    buffer_load_dwordx4 v21, s[32:35], s56 offen  lds
    s_add_u32 m0, s57, 14336
    s_nop 0
    buffer_load_dwordx4 v22, s[32:35], s56 offen  lds
    s_add_u32 m0, s57, 15360
    s_nop 0
    buffer_load_dwordx4 v23, s[32:35], s56 offen  lds
    s_lshr_b64 s[64:65], s[64:65], 4
    s_and_b32 s56, s64, 15
    s_mul_i32 s56, s56, 196608
    s_add_u32 s57, s57, 24576
    s_cmp_ge_u32 s57, 98304
    s_cselect_b32 s60, 98304, 0
    s_sub_u32 s57, s57, s60
    s_lshr_b64 s[66:67], s[66:67], 4
    s_and_b32 s58, s66, 15
    s_lshl_b32 s58, s58, 7
    s_add_u32 s59, s59, 14336
    s_cmp_ge_u32 s59, 141312
    s_cselect_b32 s60, 43008, 0
    s_sub_u32 s59, s59, s60
    s_add_u32 s61, s61, 1
    s_cmp_lt_u32 s61, 8
    s_waitcnt vmcnt(20)
    s_barrier
    s_cbranch_scc1 lg_loop
    s_waitcnt vmcnt(0)
    buffer_load_dwordx4 v[80:83], v248, s[36:39], s74 offen offset:0 sc1
    buffer_load_dwordx4 v[84:87], v248, s[36:39], s74 offen offset:1024 sc1
    buffer_load_dwordx4 v[88:91], v248, s[36:39], s74 offen offset:2048 sc1
    buffer_load_dwordx4 v[92:95], v248, s[36:39], s74 offen offset:3072 sc1
    buffer_load_dwordx4 v[96:99], v248, s[36:39], s75 offen sc1
    buffer_load_dwordx4 v[100:103], v248, s[36:39], s76 offen offset:0 sc1
    buffer_load_dwordx4 v[104:107], v248, s[36:39], s76 offen offset:1024 sc1
    buffer_load_dwordx4 v[108:111], v248, s[36:39], s76 offen offset:2048 sc1
    buffer_load_dwordx4 v[112:115], v248, s[36:39], s76 offen offset:3072 sc1
    buffer_load_dwordx4 v[116:119], v248, s[36:39], s77 offen sc1
    s_barrier
    s_branch k_gemm2
k_ldq:
    v_lshrrev_b32 v4, 1, v2
    v_xor_b32 v4, v4, v3
    s_and_b32 s51, s40, 1
    s_lshl_b32 s51, s51, 2
    v_xor_b32 v4, s51, v4
    v_lshlrev_b32 v4, 4, v4
    s_lshl_b32 s52, s40, 3
    s_add_u32 s52, s52, s41
    v_add_u32 v5, s52, v2
    v_mul_lo_u32 v6, v5, s53
    v_add_u32 v12, v6, v4
    v_xor_b32 v7, 64, v12
    v_add_u32 v13, 30720, v7
    v_add_u32 v14, 61440, v12
    v_add_u32 v15, 92160, v7
    v_add_u32 v16, 122880, v12
    v_add_u32 v17, 153600, v7
    v_add_u32 v18, 184320, v12
    v_add_u32 v19, 215040, v7
    v_cmp_gt_i32 vcc, 0, v5
    s_nop 1
    v_cndmask_b32 v12, v12, v9, vcc
    s_add_u32 s59, s54, 61440
    s_waitcnt lgkmcnt(0)
    s_mov_b32 s24, s4
    s_mov_b32 s25, s5
    s_mov_b32 s26, 2621440
    s_mov_b32 s27, 0x20000
    s_add_u32 m0, s59, 0
    s_nop 0
    buffer_load_dwordx4 v12, s[24:27], s58 offen  lds
    s_add_u32 m0, s59, 3072
    s_nop 0
    buffer_load_dwordx4 v13, s[24:27], s58 offen  lds
    s_add_u32 m0, s59, 6144
    s_nop 0
    buffer_load_dwordx4 v14, s[24:27], s58 offen  lds
    s_add_u32 m0, s59, 9216
    s_nop 0
    buffer_load_dwordx4 v15, s[24:27], s58 offen  lds
    s_add_u32 m0, s59, 12288
    s_nop 0
    buffer_load_dwordx4 v16, s[24:27], s58 offen  lds
    s_add_u32 m0, s59, 15360
    s_nop 0
    buffer_load_dwordx4 v17, s[24:27], s58 offen  lds
    s_add_u32 m0, s59, 18432
    s_nop 0
    buffer_load_dwordx4 v18, s[24:27], s58 offen  lds
    s_cmp_ge_u32 s40, 1
    s_cbranch_scc1 lq_sk1
    s_add_u32 m0, s59, 21504
    s_nop 0
    buffer_load_dwordx4 v19, s[24:27], s58 offen  lds
lq_sk1:
    s_lshr_b64 s[66:67], s[66:67], 4
    s_and_b32 s58, s66, 15
    s_lshl_b32 s58, s58, 7
    s_add_u32 s59, s59, 22528
    s_cmp_ge_u32 s59, 129024
    s_cselect_b32 s60, 67584, 0
    s_sub_u32 s59, s59, s60
    s_movk_i32 s42, 3840
    s_mov_b32 s28, s6
    s_mov_b32 s29, s7
    s_mov_b32 s30, 2457600
    s_mov_b32 s31, 0x20000
    s_mul_i32 s46, s40, 1280
    s_mul_i32 s47, s44, 160
    s_add_u32 s46, s46, s47
    v_add_u32 v4, 0, v243
    v_mul_u32_u24 v5, 205, v4
    v_lshrrev_b32 v5, 11, v5
    v_mul_u32_u24 v6, 10, v5
    v_sub_u32 v4, v4, v6
    v_lshl_add_u32 v4, v4, 4, s46
    v_lshrrev_b32 v6, 1, v5
    v_xor_b32 v6, v6, v5
    v_and_b32 v6, 4, v6
    v_mul_u32_u24 v6, 3, v6
    v_xor_b32 v5, v5, v6
    v_mad_u32_u24 v20, v5, s42, v4
    v_add_u32 v4, 64, v243
    v_mul_u32_u24 v5, 205, v4
    v_lshrrev_b32 v5, 11, v5
    v_mul_u32_u24 v6, 10, v5
    v_sub_u32 v4, v4, v6
    v_lshl_add_u32 v4, v4, 4, s46
    v_lshrrev_b32 v6, 1, v5
    v_xor_b32 v6, v6, v5
    v_and_b32 v6, 4, v6
    v_mul_u32_u24 v6, 3, v6
    v_xor_b32 v5, v5, v6
    v_mad_u32_u24 v21, v5, s42, v4
    v_add_u32 v4, 128, v243
    v_mul_u32_u24 v5, 205, v4
    v_lshrrev_b32 v5, 11, v5
    v_mul_u32_u24 v6, 10, v5
    v_sub_u32 v4, v4, v6
    v_lshl_add_u32 v4, v4, 4, s46
    v_lshrrev_b32 v6, 1, v5
    v_xor_b32 v6, v6, v5
    v_and_b32 v6, 4, v6
    v_mul_u32_u24 v6, 3, v6
    v_xor_b32 v5, v5, v6
    v_mad_u32_u24 v22, v5, s42, v4
    v_add_u32 v4, 192, v243
    v_mul_u32_u24 v5, 205, v4
    v_lshrrev_b32 v5, 11, v5
    v_mul_u32_u24 v6, 10, v5
    v_sub_u32 v4, v4, v6
    v_lshl_add_u32 v4, v4, 4, s46
    v_lshrrev_b32 v6, 1, v5
    v_xor_b32 v6, v6, v5
    v_and_b32 v6, 4, v6
    v_mul_u32_u24 v6, 3, v6
    v_xor_b32 v5, v5, v6
    v_mad_u32_u24 v23, v5, s42, v4
    v_add_u32 v4, 256, v243
    v_mul_u32_u24 v5, 205, v4
    v_lshrrev_b32 v5, 11, v5
    v_mul_u32_u24 v6, 10, v5
    v_sub_u32 v4, v4, v6
    v_lshl_add_u32 v4, v4, 4, s46
    v_lshrrev_b32 v6, 1, v5
    v_xor_b32 v6, v6, v5
    v_and_b32 v6, 4, v6
    v_mul_u32_u24 v6, 3, v6
    v_xor_b32 v5, v5, v6
    v_mad_u32_u24 v24, v5, s42, v4
    s_mul_i32 s57, s40, 5120
    s_mul_i32 s56, s68, 245760
    s_add_u32 m0, s57, 0
    s_nop 0
    buffer_load_dwordx4 v20, s[28:31], s56 offen  lds
    s_add_u32 m0, s57, 1024
    s_nop 0
    buffer_load_dwordx4 v21, s[28:31], s56 offen  lds
    s_add_u32 m0, s57, 2048
    s_nop 0
    buffer_load_dwordx4 v22, s[28:31], s56 offen  lds
    s_add_u32 m0, s57, 3072
    s_nop 0
    buffer_load_dwordx4 v23, s[28:31], s56 offen  lds
    s_add_u32 m0, s57, 4096
    s_nop 0
    buffer_load_dwordx4 v24, s[28:31], s56 offen  lds
    s_add_u32 s56, s56, 122880
    s_add_u32 s57, s57, 15360
    s_cmp_ge_u32 s57, 61440
    s_cselect_b32 s60, 61440, 0
    s_sub_u32 s57, s57, s60
    s_add_u32 m0, s57, 0
    s_nop 0
    buffer_load_dwordx4 v20, s[28:31], s56 offen  lds
    s_add_u32 m0, s57, 1024
    s_nop 0
    buffer_load_dwordx4 v21, s[28:31], s56 offen  lds
    s_add_u32 m0, s57, 2048
    s_nop 0
    buffer_load_dwordx4 v22, s[28:31], s56 offen  lds
    s_add_u32 m0, s57, 3072
    s_nop 0
    buffer_load_dwordx4 v23, s[28:31], s56 offen  lds
    s_add_u32 m0, s57, 4096
    s_nop 0
    buffer_load_dwordx4 v24, s[28:31], s56 offen  lds
    s_lshr_b64 s[64:65], s[64:65], 4
    s_and_b32 s56, s64, 15
    s_mul_i32 s56, s56, 245760
    s_add_u32 s57, s57, 15360
    s_cmp_ge_u32 s57, 61440
    s_cselect_b32 s60, 61440, 0
    s_sub_u32 s57, s57, s60
    s_add_u32 s10, s22, 21037056
    s_addc_u32 s11, s23, 0
    s_add_u32 s36, s22, 9437184
    s_addc_u32 s37, s23, 0
    s_mov_b32 s38, 2785280
    s_mov_b32 s39, 0x20000
    v_lshlrev_b32 v248, 4, v243
    s_lshr_b32 s47, s2, 6
    s_bfe_u32 s48, s2, 0x30003
    s_mul_i32 s49, s48, 348160
    s_mul_i32 s50, s40, 87040
    s_add_u32 s49, s49, s50
    s_lshl_b32 s47, s47, 1
    s_add_u32 s48, s48, s47
    s_add_u32 s74, s48, 0
    s_and_b32 s74, s74, 7
    s_mul_i32 s74, s74, 5120
    s_add_u32 s74, s74, s49
    s_add_u32 s75, s74, 4096
    s_add_u32 s76, s48, 1
    s_and_b32 s76, s76, 7
    s_mul_i32 s76, s76, 5120
    s_add_u32 s76, s76, s49
    s_add_u32 s77, s76, 4096
    s_waitcnt vmcnt(5)
    s_barrier
    s_add_u32 m0, s57, 0
    s_nop 0
    buffer_load_dwordx4 v20, s[28:31], s56 offen  lds
    s_add_u32 m0, s57, 1024
    s_nop 0
    buffer_load_dwordx4 v21, s[28:31], s56 offen  lds
    s_add_u32 m0, s57, 2048
    s_nop 0
    buffer_load_dwordx4 v22, s[28:31], s56 offen  lds
    s_add_u32 m0, s57, 3072
    s_nop 0
    buffer_load_dwordx4 v23, s[28:31], s56 offen  lds
    s_add_u32 m0, s57, 4096
    s_nop 0
    buffer_load_dwordx4 v24, s[28:31], s56 offen  lds
    s_add_u32 s56, s56, 122880
    s_add_u32 s57, s57, 15360
    s_cmp_ge_u32 s57, 61440
    s_cselect_b32 s60, 61440, 0
    s_sub_u32 s57, s57, s60
    s_waitcnt vmcnt(5)
    s_barrier
    s_add_u32 m0, s59, 0
    s_nop 0
    buffer_load_dwordx4 v12, s[24:27], s58 offen  lds
    s_add_u32 m0, s59, 3072
    s_nop 0
    buffer_load_dwordx4 v13, s[24:27], s58 offen  lds
    s_add_u32 m0, s59, 6144
    s_nop 0
    buffer_load_dwordx4 v14, s[24:27], s58 offen  lds
    s_add_u32 m0, s59, 9216
    s_nop 0
    buffer_load_dwordx4 v15, s[24:27], s58 offen  lds
    s_add_u32 m0, s59, 12288
    s_nop 0
    buffer_load_dwordx4 v16, s[24:27], s58 offen  lds
    s_add_u32 m0, s59, 15360
    s_nop 0
    buffer_load_dwordx4 v17, s[24:27], s58 offen  lds
    s_add_u32 m0, s59, 18432
    s_nop 0
    buffer_load_dwordx4 v18, s[24:27], s58 offen  lds
    s_cmp_ge_u32 s40, 1
    s_cbranch_scc1 lq_sk2
    s_add_u32 m0, s59, 21504
    s_nop 0
    buffer_load_dwordx4 v19, s[24:27], s58 offen  lds
lq_sk2:
    s_lshr_b64 s[66:67], s[66:67], 4
    s_and_b32 s58, s66, 15
    s_lshl_b32 s58, s58, 7
    s_add_u32 s59, s59, 22528
    s_cmp_ge_u32 s59, 129024
    s_cselect_b32 s60, 67584, 0
    s_sub_u32 s59, s59, s60
    s_add_u32 m0, s57, 0
    s_nop 0
    buffer_load_dwordx4 v20, s[28:31], s56 offen  lds
    s_add_u32 m0, s57, 1024
    s_nop 0
    buffer_load_dwordx4 v21, s[28:31], s56 offen  lds
    s_add_u32 m0, s57, 2048
    s_nop 0
    buffer_load_dwordx4 v22, s[28:31], s56 offen  lds
    s_add_u32 m0, s57, 3072
    s_nop 0
    buffer_load_dwordx4 v23, s[28:31], s56 offen  lds
    s_add_u32 m0, s57, 4096
    s_nop 0
    buffer_load_dwordx4 v24, s[28:31], s56 offen  lds
    s_lshr_b64 s[64:65], s[64:65], 4
    s_and_b32 s56, s64, 15
    s_mul_i32 s56, s56, 245760
    s_add_u32 s57, s57, 15360
    s_cmp_ge_u32 s57, 61440
    s_cselect_b32 s60, 61440, 0
    s_sub_u32 s57, s57, s60
lq_loop:
    s_add_u32 m0, s57, 0
    s_nop 0
    buffer_load_dwordx4 v20, s[28:31], s56 offen  lds
    s_add_u32 m0, s57, 1024
    s_nop 0
    buffer_load_dwordx4 v21, s[28:31], s56 offen  lds
    s_add_u32 m0, s57, 2048
    s_nop 0
    buffer_load_dwordx4 v22, s[28:31], s56 offen  lds
    s_add_u32 m0, s57, 3072
    s_nop 0
    buffer_load_dwordx4 v23, s[28:31], s56 offen  lds
    s_add_u32 m0, s57, 4096
    s_nop 0
    buffer_load_dwordx4 v24, s[28:31], s56 offen  lds
    s_add_u32 m0, s59, 0
    s_nop 0
    buffer_load_dwordx4 v12, s[24:27], s58 offen  lds
    s_add_u32 m0, s59, 3072
    s_nop 0
    buffer_load_dwordx4 v13, s[24:27], s58 offen  lds
    s_add_u32 m0, s59, 6144
    s_nop 0
    buffer_load_dwordx4 v14, s[24:27], s58 offen  lds
    s_add_u32 m0, s59, 9216
    s_nop 0
    buffer_load_dwordx4 v15, s[24:27], s58 offen  lds
    s_add_u32 s56, s56, 122880
    s_add_u32 s57, s57, 15360
    s_cmp_ge_u32 s57, 61440
    s_cselect_b32 s60, 61440, 0
    s_sub_u32 s57, s57, s60
    s_waitcnt vmcnt(14)
    s_barrier
    s_add_u32 m0, s59, 12288
    s_nop 0
    buffer_load_dwordx4 v16, s[24:27], s58 offen  lds
    s_add_u32 m0, s59, 15360
    s_nop 0
    buffer_load_dwordx4 v17, s[24:27], s58 offen  lds
    s_add_u32 m0, s59, 18432
    s_nop 0
    buffer_load_dwordx4 v18, s[24:27], s58 offen  lds
    s_cmp_ge_u32 s40, 1
    s_cbranch_scc1 lq_sk3
    s_add_u32 m0, s59, 21504
    s_nop 0
    buffer_load_dwordx4 v19, s[24:27], s58 offen  lds
lq_sk3:
    s_add_u32 m0, s57, 0
    s_nop 0
    buffer_load_dwordx4 v20, s[28:31], s56 offen  lds
    s_add_u32 m0, s57, 1024
    s_nop 0
    buffer_load_dwordx4 v21, s[28:31], s56 offen  lds
    s_add_u32 m0, s57, 2048
    s_nop 0
    buffer_load_dwordx4 v22, s[28:31], s56 offen  lds
    s_add_u32 m0, s57, 3072
    s_nop 0
    buffer_load_dwordx4 v23, s[28:31], s56 offen  lds
    s_add_u32 m0, s57, 4096
    s_nop 0
    buffer_load_dwordx4 v24, s[28:31], s56 offen  lds
    s_lshr_b64 s[64:65], s[64:65], 4
    s_and_b32 s56, s64, 15
    s_mul_i32 s56, s56, 245760
    s_add_u32 s57, s57, 15360
    s_cmp_ge_u32 s57, 61440
    s_cselect_b32 s60, 61440, 0
    s_sub_u32 s57, s57, s60
    s_lshr_b64 s[66:67], s[66:67], 4
    s_and_b32 s58, s66, 15
    s_lshl_b32 s58, s58, 7
    s_add_u32 s59, s59, 22528
    s_cmp_ge_u32 s59, 129024
    s_cselect_b32 s60, 67584, 0
    s_sub_u32 s59, s59, s60
    s_add_u32 s61, s61, 1
    s_cmp_lt_u32 s61, 8
    s_waitcnt vmcnt(17)
    s_barrier
    s_cbranch_scc1 lq_loop
    s_waitcnt vmcnt(0)
    buffer_load_dwordx4 v[80:83], v248, s[36:39], s74 offen offset:0 sc1
    buffer_load_dwordx4 v[84:87], v248, s[36:39], s74 offen offset:1024 sc1
    buffer_load_dwordx4 v[88:91], v248, s[36:39], s74 offen offset:2048 sc1
    buffer_load_dwordx4 v[92:95], v248, s[36:39], s74 offen offset:3072 sc1
    buffer_load_dwordx4 v[96:99], v248, s[36:39], s75 offen sc1
    buffer_load_dwordx4 v[100:103], v248, s[36:39], s76 offen offset:0 sc1
    buffer_load_dwordx4 v[104:107], v248, s[36:39], s76 offen offset:1024 sc1
    buffer_load_dwordx4 v[108:111], v248, s[36:39], s76 offen offset:2048 sc1
    buffer_load_dwordx4 v[112:115], v248, s[36:39], s76 offen offset:3072 sc1
    buffer_load_dwordx4 v[116:119], v248, s[36:39], s77 offen sc1
    s_barrier
k_gemm2:
    s_and_b32 s41, s2, 7
    s_lshl_b32 s41, s41, 2
    s_lshr_b32 s47, s2, 6
    s_add_u32 s41, s41, s47
    s_bfe_u32 s42, s2, 0x30003
    s_mov_b32 s48, s42
    v_lshlrev_b32 v248, 4, v243
    s_add_u32 s28, s22, 9437184
    s_addc_u32 s29, s23, 0
    s_mov_b32 s30, 2785280
    s_mov_b32 s31, 0x20000
    s_mul_i32 s52, s42, 348160
    s_mul_i32 s46, s40, 87040
    s_add_u32 s52, s52, s46
    s_lshl_b32 s56, s47, 1
    s_add_u32 s56, s56, s48
    s_add_u32 s57, s48, s47
    s_mul_i32 s62, s40, 35840
    s_add_u32 s55, s56, 2
    s_and_b32 s55, s55, 7
    s_mul_i32 s55, s55, 5120
    s_add_u32 s55, s55, s52
    s_add_u32 s54, s55, 4096
    buffer_load_dwordx4 v[120:123], v248, s[28:31], s55 offen offset:0 sc1
    buffer_load_dwordx4 v[124:127], v248, s[28:31], s55 offen offset:1024 sc1
    buffer_load_dwordx4 v[128:131], v248, s[28:31], s55 offen offset:2048 sc1
    buffer_load_dwordx4 v[132:135], v248, s[28:31], s55 offen offset:3072 sc1
    buffer_load_dwordx4 v[136:139], v248, s[28:31], s54 offen sc1
    s_add_u32 s55, s56, 4
    s_and_b32 s55, s55, 7
    s_mul_i32 s55, s55, 5120
    s_add_u32 s55, s55, s52
    s_add_u32 s54, s55, 4096
    buffer_load_dwordx4 v[140:143], v248, s[28:31], s55 offen offset:0 sc1
    buffer_load_dwordx4 v[144:147], v248, s[28:31], s55 offen offset:1024 sc1
    buffer_load_dwordx4 v[148:151], v248, s[28:31], s55 offen offset:2048 sc1
    buffer_load_dwordx4 v[152:155], v248, s[28:31], s55 offen offset:3072 sc1
    buffer_load_dwordx4 v[156:159], v248, s[28:31], s54 offen sc1
    s_add_u32 s55, s56, 7
    s_and_b32 s55, s55, 7
    s_mul_i32 s55, s55, 5120
    s_add_u32 s55, s55, s52
    s_add_u32 s54, s55, 4096
    buffer_load_dwordx4 v[160:163], v248, s[28:31], s55 offen offset:0 sc1
    buffer_load_dwordx4 v[164:167], v248, s[28:31], s55 offen offset:1024 sc1
    buffer_load_dwordx4 v[168:171], v248, s[28:31], s55 offen offset:2048 sc1
    buffer_load_dwordx4 v[172:175], v248, s[28:31], s55 offen offset:3072 sc1
    buffer_load_dwordx4 v[176:179], v248, s[28:31], s54 offen sc1
    s_add_u32 s55, s57, 10
    s_and_b32 s55, s55, 3
    s_add_u32 s55, s55, 8
    s_mul_i32 s55, s55, 5120
    s_add_u32 s55, s55, s52
    s_add_u32 s54, s55, 4096
    buffer_load_dwordx4 v[180:183], v248, s[28:31], s55 offen offset:0 sc1
    buffer_load_dwordx4 v[184:187], v248, s[28:31], s55 offen offset:1024 sc1
    buffer_load_dwordx4 v[188:191], v248, s[28:31], s55 offen offset:2048 sc1
    buffer_load_dwordx4 v[192:195], v248, s[28:31], s55 offen offset:3072 sc1
    buffer_load_dwordx4 v[196:199], v248, s[28:31], s54 offen sc1
    v_add_u32 v249, s62, v248
    v_bfe_u32 v2, v243, 2, 2
    v_lshrrev_b32 v3, 4, v243
    v_lshlrev_b32 v2, 8, v2
    v_lshl_add_u32 v2, v3, 6, v2
    v_and_b32 v3, 3, v243
    v_lshl_add_u32 v2, v3, 4, v2
    s_add_u32 s47, s40, 0
    s_and_b32 s47, s47, 3
    s_lshl_b32 s47, s47, 10
    v_add_u32 v250, s47, v2
    s_add_u32 s47, s40, 1
    s_and_b32 s47, s47, 3
    s_lshl_b32 s47, s47, 10
    v_add_u32 v251, s47, v2
    s_add_u32 s47, s40, 2
    s_and_b32 s47, s47, 3
    s_lshl_b32 s47, s47, 10
    v_add_u32 v252, s47, v2
    s_add_u32 s47, s40, 3
    s_and_b32 s47, s47, 3
    s_lshl_b32 s47, s47, 10
    v_add_u32 v253, s47, v2
    s_mov_b32 s24, s22
    s_mov_b32 s25, s23
    s_mov_b32 s26, 8912896
    s_mov_b32 s27, 0x20000
    s_mov_b32 s32, s4
    s_mov_b32 s33, s5
    s_mov_b32 s34, 2621440
    s_mov_b32 s35, 0x20000
    s_mov_b32 s36, s18
    s_mov_b32 s37, s19
    s_mov_b32 s38, 2621440
    s_mov_b32 s39, 0x20000
    s_mul_i32 s50, s41, 278528
    s_mul_i32 s46, s40, 69632
    s_add_u32 s50, s50, s46
    v_and_b32 v2, 15, v243
    v_lshrrev_b32 v3, 4, v243
    s_lshl_b32 s47, s41, 6
    s_lshl_b32 s58, s40, 4
    s_add_u32 s58, s47, s58
    v_add_u32 v2, s58, v2
    s_movk_i32 s58, 1280
    s_mul_i32 s59, s42, 160
    v_mul_lo_u32 v2, v2, s58
    v_add_u32 v2, s59, v2
    v_lshl_add_u32 v254, v3, 4, v2
    v_lshl_add_u32 v255, v3, 3, v2
    s_lshl_b32 s61, s40, 1
    s_lshl_b32 s61, 3, s61
    s_add_u32 s48, s47, 63
    s_mul_i32 s58, s47, 607
    s_lshr_b32 s58, s58, 16
    s_mul_i32 s59, s48, 607
    s_lshr_b32 s59, s59, 16
    s_cmp_lg_u32 s58, s59
    s_movk_i32 s64, 0x44
    s_cselect_b32 s64, 0x4444, s64
    s_add_u32 s48, s47, 48
    s_mul_i32 s58, s47, 410
    s_lshr_b32 s58, s58, 16
    s_mul_i32 s59, s48, 410
    s_lshr_b32 s59, s59, 16
    s_cmp_lg_u32 s58, s59
    s_movk_i32 s66, 0x44
    s_cselect_b32 s66, 0x4444, s66
    s_lshl_b32 s67, s64, 16
    s_lshl_b32 s65, s41, 2
    s_add_u32 s65, s65, s40
    s_add_u32 s65, s65, 32
    s_mul_i32 s65, s65, 256
    s_add_u32 s61, s65, 128
    s_add_u32 s3, s56, 0
    s_and_b32 s3, s3, 7
    s_mul_i32 s3, s3, 4096
    s_add_u32 s3, s3, s50
    s_add_u32 s4, s56, 1
    s_and_b32 s4, s4, 7
    s_mul_i32 s4, s4, 4096
    s_add_u32 s4, s4, s50
    s_add_u32 s5, s56, 2
    s_and_b32 s5, s5, 7
    s_mul_i32 s5, s5, 4096
    s_add_u32 s5, s5, s50
    s_add_u32 s6, s56, 3
    s_and_b32 s6, s6, 7
    s_mul_i32 s6, s6, 4096
    s_add_u32 s6, s6, s50
    s_add_u32 s7, s56, 4
    s_and_b32 s7, s7, 7
    s_mul_i32 s7, s7, 4096
    s_add_u32 s7, s7, s50
    s_add_u32 s8, s56, 5
    s_and_b32 s8, s8, 7
    s_mul_i32 s8, s8, 4096
    s_add_u32 s8, s8, s50
    s_add_u32 s9, s56, 6
    s_and_b32 s9, s9, 7
    s_mul_i32 s9, s9, 4096
    s_add_u32 s9, s9, s50
    s_add_u32 s12, s56, 7
    s_and_b32 s12, s12, 7
    s_mul_i32 s12, s12, 4096
    s_add_u32 s12, s12, s50
    s_add_u32 s13, s57, 8
    s_and_b32 s13, s13, 3
    s_add_u32 s13, s13, 8
    s_mul_i32 s13, s13, 4096
    s_add_u32 s13, s13, s50
    s_add_u32 s14, s57, 9
    s_and_b32 s14, s14, 3
    s_add_u32 s14, s14, 8
    s_mul_i32 s14, s14, 4096
    s_add_u32 s14, s14, s50
    s_add_u32 s15, s57, 10
    s_and_b32 s15, s15, 3
    s_add_u32 s15, s15, 8
    s_mul_i32 s15, s15, 4096
    s_add_u32 s15, s15, s50
    s_add_u32 s16, s57, 11
    s_and_b32 s16, s16, 3
    s_add_u32 s16, s16, 8
    s_mul_i32 s16, s16, 4096
    s_add_u32 s16, s16, s50
    s_add_u32 s17, s57, 12
    s_and_b32 s17, s17, 3
    s_add_u32 s17, s17, 12
    s_mul_i32 s17, s17, 4096
    s_add_u32 s17, s17, s50
    s_add_u32 s18, s57, 13
    s_and_b32 s18, s18, 3
    s_add_u32 s18, s18, 12
    s_mul_i32 s18, s18, 4096
    s_add_u32 s18, s18, s50
    s_add_u32 s19, s57, 14
    s_and_b32 s19, s19, 3
    s_add_u32 s19, s19, 12
    s_mul_i32 s19, s19, 4096
    s_add_u32 s19, s19, s50
    s_add_u32 s20, s57, 15
    s_and_b32 s20, s20, 3
    s_add_u32 s20, s20, 12
    s_mul_i32 s20, s20, 4096
    s_add_u32 s20, s20, s50
    s_add_u32 s21, s50, 65536
    s_add_u32 s72, s56, 5
    s_and_b32 s72, s72, 7
    s_mul_i32 s72, s72, 5120
    s_add_u32 s72, s72, s52
    s_add_u32 s73, s72, 4096
    s_add_u32 s74, s57, 8
    s_and_b32 s74, s74, 3
    s_add_u32 s74, s74, 8
    s_mul_i32 s74, s74, 5120
    s_add_u32 s74, s74, s52
    s_add_u32 s75, s74, 4096
    s_add_u32 s76, s57, 11
    s_and_b32 s76, s76, 3
    s_add_u32 s76, s76, 8
    s_mul_i32 s76, s76, 5120
    s_add_u32 s76, s76, s52
    s_add_u32 s77, s76, 4096
    s_add_u32 s78, s57, 14
    s_and_b32 s78, s78, 3
    s_add_u32 s78, s78, 12
    s_mul_i32 s78, s78, 5120
    s_add_u32 s78, s78, s52
    s_add_u32 s79, s78, 4096
    v_and_b32 v2, 1, v243
    v_cmp_eq_u32 s[68:69], 1, v2
    v_mov_b32 v0, 160260
    s_mov_b32 s70, 0
lw1:
    ds_read_b32 v1, v0
    s_waitcnt lgkmcnt(0)
    v_readfirstlane_b32 s71, v1
    s_nop 0
    s_cmp_ge_u32 s71, 4
    s_cbranch_scc1 lw1_ok
    s_sleep 1
    s_add_u32 s70, s70, 1
    s_cmp_lt_u32 s70, 200000
    s_cbranch_scc1 lw1
    s_endpgm
lw1_ok:
    s_add_u32 s55, s56, 3
    s_and_b32 s55, s55, 7
    s_mul_i32 s55, s55, 5120
    s_add_u32 s55, s55, s52
    s_add_u32 s54, s55, 4096
    s_add_u32 m0, s62, 0
    s_nop 0
    buffer_load_dwordx4 v248, s[28:31], s55 offen offset:0 sc1  lds
    buffer_load_dwordx4 v248, s[28:31], s55 offen offset:1024 sc1  lds
    buffer_load_dwordx4 v248, s[28:31], s55 offen offset:2048 sc1  lds
    buffer_load_dwordx4 v248, s[28:31], s55 offen offset:3072 sc1  lds
    s_add_u32 m0, s62, 4096
    s_nop 0
    buffer_load_dwordx4 v248, s[28:31], s54 offen sc1  lds
    s_add_u32 s55, s56, 6
    s_and_b32 s55, s55, 7
    s_mul_i32 s55, s55, 5120
    s_add_u32 s55, s55, s52
    s_add_u32 s54, s55, 4096
    s_add_u32 m0, s62, 5120
    s_nop 0
    buffer_load_dwordx4 v248, s[28:31], s55 offen offset:0 sc1  lds
    buffer_load_dwordx4 v248, s[28:31], s55 offen offset:1024 sc1  lds
    buffer_load_dwordx4 v248, s[28:31], s55 offen offset:2048 sc1  lds
    buffer_load_dwordx4 v248, s[28:31], s55 offen offset:3072 sc1  lds
    s_add_u32 m0, s62, 9216
    s_nop 0
    buffer_load_dwordx4 v248, s[28:31], s54 offen sc1  lds
    s_add_u32 s55, s57, 9
    s_and_b32 s55, s55, 3
    s_add_u32 s55, s55, 8
    s_mul_i32 s55, s55, 5120
    s_add_u32 s55, s55, s52
    s_add_u32 s54, s55, 4096
    s_add_u32 m0, s62, 10240
    s_nop 0
    buffer_load_dwordx4 v248, s[28:31], s55 offen offset:0 sc1  lds
    buffer_load_dwordx4 v248, s[28:31], s55 offen offset:1024 sc1  lds
    buffer_load_dwordx4 v248, s[28:31], s55 offen offset:2048 sc1  lds
    buffer_load_dwordx4 v248, s[28:31], s55 offen offset:3072 sc1  lds
    s_add_u32 m0, s62, 14336
    s_nop 0
    buffer_load_dwordx4 v248, s[28:31], s54 offen sc1  lds
    s_add_u32 s55, s57, 12
    s_and_b32 s55, s55, 3
    s_add_u32 s55, s55, 12
    s_mul_i32 s55, s55, 5120
    s_add_u32 s55, s55, s52
    s_add_u32 s54, s55, 4096
    s_add_u32 m0, s62, 15360
    s_nop 0
    buffer_load_dwordx4 v248, s[28:31], s55 offen offset:0 sc1  lds
    buffer_load_dwordx4 v248, s[28:31], s55 offen offset:1024 sc1  lds
    buffer_load_dwordx4 v248, s[28:31], s55 offen offset:2048 sc1  lds
    buffer_load_dwordx4 v248, s[28:31], s55 offen offset:3072 sc1  lds
    s_add_u32 m0, s62, 19456
    s_nop 0
    buffer_load_dwordx4 v248, s[28:31], s54 offen sc1  lds
    s_add_u32 s55, s57, 13
    s_and_b32 s55, s55, 3
    s_add_u32 s55, s55, 12
    s_mul_i32 s55, s55, 5120
    s_add_u32 s55, s55, s52
    s_add_u32 s54, s55, 4096
    s_add_u32 m0, s62, 20480
    s_nop 0
    buffer_load_dwordx4 v248, s[28:31], s55 offen offset:0 sc1  lds
    buffer_load_dwordx4 v248, s[28:31], s55 offen offset:1024 sc1  lds
    buffer_load_dwordx4 v248, s[28:31], s55 offen offset:2048 sc1  lds
    buffer_load_dwordx4 v248, s[28:31], s55 offen offset:3072 sc1  lds
    s_add_u32 m0, s62, 24576
    s_nop 0
    buffer_load_dwordx4 v248, s[28:31], s54 offen sc1  lds
    s_add_u32 s55, s57, 15
    s_and_b32 s55, s55, 3
    s_add_u32 s55, s55, 12
    s_mul_i32 s55, s55, 5120
    s_add_u32 s55, s55, s52
    s_add_u32 s54, s55, 4096
    s_add_u32 m0, s62, 25600
    s_nop 0
    buffer_load_dwordx4 v248, s[28:31], s55 offen offset:0 sc1  lds
    buffer_load_dwordx4 v248, s[28:31], s55 offen offset:1024 sc1  lds
    buffer_load_dwordx4 v248, s[28:31], s55 offen offset:2048 sc1  lds
    buffer_load_dwordx4 v248, s[28:31], s55 offen offset:3072 sc1  lds
    s_add_u32 m0, s62, 29696
    s_nop 0
    buffer_load_dwordx4 v248, s[28:31], s54 offen sc1  lds
    s_add_u32 s55, s52, 81920
    s_add_u32 s54, s55, 4096
    s_add_u32 m0, s62, 30720
    s_nop 0
    buffer_load_dwordx4 v248, s[28:31], s55 offen offset:0 sc1  lds
    buffer_load_dwordx4 v248, s[28:31], s55 offen offset:1024 sc1  lds
    buffer_load_dwordx4 v248, s[28:31], s55 offen offset:2048 sc1  lds
    s_waitcnt vmcnt(62)
    buffer_load_dwordx4 v248, s[28:31], s55 offen offset:3072 sc1  lds
    s_add_u32 m0, s62, 34816
    s_waitcnt vmcnt(62)
    buffer_load_dwordx4 v248, s[28:31], s54 offen sc1  lds
    s_mov_b32 s70, 0
sp_top:
    s_mov_b32 s71, 0
    s_atomic_add s71, s[10:11], s65 glc
    s_waitcnt lgkmcnt(0)
    s_and_b32 s71, s71, s64
    s_cmp_eq_u32 s71, s64
    s_cbranch_scc1 sp_ok
    s_sleep 2
    s_add_u32 s70, s70, 1
    s_cmp_lt_u32 s70, 30000
    s_cbranch_scc1 sp_top
    s_endpgm
sp_ok:
    s_waitcnt vmcnt(62)
    buffer_load_dwordx4 v[200:203], v250, s[24:27], s3 offen sc1
    s_waitcnt vmcnt(62)
    buffer_load_dwordx4 v[204:207], v251, s[24:27], s3 offen sc1
    s_waitcnt vmcnt(62)
    buffer_load_dwordx4 v[208:211], v252, s[24:27], s3 offen sc1
    s_waitcnt vmcnt(62)
    buffer_load_dwordx4 v[212:215], v253, s[24:27], s3 offen sc1
    s_waitcnt vmcnt(62)
    buffer_load_dwordx4 v[216:219], v250, s[24:27], s4 offen sc1
    s_waitcnt vmcnt(62)
    buffer_load_dwordx4 v[220:223], v251, s[24:27], s4 offen sc1
    s_waitcnt vmcnt(62)
    buffer_load_dwordx4 v[224:227], v252, s[24:27], s4 offen sc1
    s_waitcnt vmcnt(62)
    buffer_load_dwordx4 v[228:231], v253, s[24:27], s4 offen sc1
    s_waitcnt vmcnt(62)
    buffer_load_dwordx4 v[232:235], v250, s[24:27], s5 offen sc1
    s_waitcnt vmcnt(62)
    buffer_load_dwordx4 v[236:239], v251, s[24:27], s5 offen sc1
    s_waitcnt vmcnt(62)
    buffer_load_dwordx4 v[240:243], v252, s[24:27], s5 offen sc1
    s_waitcnt vmcnt(62)
    buffer_load_dwordx4 v[244:247], v253, s[24:27], s5 offen sc1
    s_waitcnt vmcnt(8)
    v_mfma_f32_16x16x32_bf16 v[0:3], v[80:83], v[200:203], 0
    v_mfma_f32_16x16x32_bf16 v[4:7], v[84:87], v[200:203], 0
    v_mfma_f32_16x16x32_bf16 v[8:11], v[88:91], v[200:203], 0
    v_mfma_f32_16x16x32_bf16 v[12:15], v[92:95], v[200:203], 0
    v_mfma_f32_16x16x32_bf16 v[16:19], v[96:99], v[200:203], 0
    v_mfma_f32_16x16x32_bf16 v[20:23], v[80:83], v[204:207], 0
    v_mfma_f32_16x16x32_bf16 v[24:27], v[84:87], v[204:207], 0
    v_mfma_f32_16x16x32_bf16 v[28:31], v[88:91], v[204:207], 0
    v_mfma_f32_16x16x32_bf16 v[32:35], v[92:95], v[204:207], 0
    v_mfma_f32_16x16x32_bf16 v[36:39], v[96:99], v[204:207], 0
    v_mfma_f32_16x16x32_bf16 v[40:43], v[80:83], v[208:211], 0
    v_mfma_f32_16x16x32_bf16 v[44:47], v[84:87], v[208:211], 0
    v_mfma_f32_16x16x32_bf16 v[48:51], v[88:91], v[208:211], 0
    v_mfma_f32_16x16x32_bf16 v[52:55], v[92:95], v[208:211], 0
    v_mfma_f32_16x16x32_bf16 v[56:59], v[96:99], v[208:211], 0
    v_mfma_f32_16x16x32_bf16 v[60:63], v[80:83], v[212:215], 0
    v_mfma_f32_16x16x32_bf16 v[64:67], v[84:87], v[212:215], 0
    v_mfma_f32_16x16x32_bf16 v[68:71], v[88:91], v[212:215], 0
    v_mfma_f32_16x16x32_bf16 v[72:75], v[92:95], v[212:215], 0
    v_mfma_f32_16x16x32_bf16 v[76:79], v[96:99], v[212:215], 0
    s_waitcnt vmcnt(4)
    v_mfma_f32_16x16x32_bf16 v[0:3], v[100:103], v[216:219], v[0:3]
    buffer_load_dwordx4 v[200:203], v250, s[24:27], s6 offen sc1
    v_mfma_f32_16x16x32_bf16 v[4:7], v[104:107], v[216:219], v[4:7]
    v_mfma_f32_16x16x32_bf16 v[8:11], v[108:111], v[216:219], v[8:11]
    v_mfma_f32_16x16x32_bf16 v[12:15], v[112:115], v[216:219], v[12:15]
    buffer_load_dwordx4 v[204:207], v251, s[24:27], s6 offen sc1
    v_mfma_f32_16x16x32_bf16 v[16:19], v[116:119], v[216:219], v[16:19]
    v_mfma_f32_16x16x32_bf16 v[20:23], v[100:103], v[220:223], v[20:23]
    v_mfma_f32_16x16x32_bf16 v[24:27], v[104:107], v[220:223], v[24:27]
    buffer_load_dwordx4 v[208:211], v252, s[24:27], s6 offen sc1
    v_mfma_f32_16x16x32_bf16 v[28:31], v[108:111], v[220:223], v[28:31]
    v_mfma_f32_16x16x32_bf16 v[32:35], v[112:115], v[220:223], v[32:35]
    v_mfma_f32_16x16x32_bf16 v[36:39], v[116:119], v[220:223], v[36:39]
    buffer_load_dwordx4 v[212:215], v253, s[24:27], s6 offen sc1
    v_mfma_f32_16x16x32_bf16 v[40:43], v[100:103], v[224:227], v[40:43]
    v_mfma_f32_16x16x32_bf16 v[44:47], v[104:107], v[224:227], v[44:47]
    v_mfma_f32_16x16x32_bf16 v[48:51], v[108:111], v[224:227], v[48:51]
    buffer_load_dwordx4 v[80:83], v250, s[24:27], s7 offen sc1
    v_mfma_f32_16x16x32_bf16 v[52:55], v[112:115], v[224:227], v[52:55]
    v_mfma_f32_16x16x32_bf16 v[56:59], v[116:119], v[224:227], v[56:59]
    v_mfma_f32_16x16x32_bf16 v[60:63], v[100:103], v[228:231], v[60:63]
    buffer_load_dwordx4 v[84:87], v251, s[24:27], s7 offen sc1
    v_mfma_f32_16x16x32_bf16 v[64:67], v[104:107], v[228:231], v[64:67]
    v_mfma_f32_16x16x32_bf16 v[68:71], v[108:111], v[228:231], v[68:71]
    v_mfma_f32_16x16x32_bf16 v[72:75], v[112:115], v[228:231], v[72:75]
    buffer_load_dwordx4 v[88:91], v252, s[24:27], s7 offen sc1
    v_mfma_f32_16x16x32_bf16 v[76:79], v[116:119], v[228:231], v[76:79]
    s_waitcnt vmcnt(7)
    v_mfma_f32_16x16x32_bf16 v[0:3], v[120:123], v[232:235], v[0:3]
    buffer_load_dwordx4 v[92:95], v253, s[24:27], s7 offen sc1
    v_mfma_f32_16x16x32_bf16 v[4:7], v[124:127], v[232:235], v[4:7]
    ds_read_b128 v[100:103], v249 offset:0
    v_mfma_f32_16x16x32_bf16 v[8:11], v[128:131], v[232:235], v[8:11]
    ds_read_b128 v[104:107], v249 offset:1024
    v_mfma_f32_16x16x32_bf16 v[12:15], v[132:135], v[232:235], v[12:15]
    buffer_load_dwordx4 v[96:99], v248, s[28:31], s72 offen offset:0 sc1
    v_mfma_f32_16x16x32_bf16 v[16:19], v[136:139], v[232:235], v[16:19]
    ds_read_b128 v[108:111], v249 offset:2048
    v_mfma_f32_16x16x32_bf16 v[20:23], v[120:123], v[236:239], v[20:23]
    ds_read_b128 v[112:115], v249 offset:3072
    v_mfma_f32_16x16x32_bf16 v[24:27], v[124:127], v[236:239], v[24:27]
    buffer_load_dwordx4 v[216:219], v248, s[28:31], s72 offen offset:1024 sc1
    v_mfma_f32_16x16x32_bf16 v[28:31], v[128:131], v[236:239], v[28:31]
    ds_read_b128 v[116:119], v249 offset:4096
    v_mfma_f32_16x16x32_bf16 v[32:35], v[132:135], v[236:239], v[32:35]
    v_mfma_f32_16x16x32_bf16 v[36:39], v[136:139], v[236:239], v[36:39]
    buffer_load_dwordx4 v[220:223], v248, s[28:31], s72 offen offset:2048 sc1
    v_mfma_f32_16x16x32_bf16 v[40:43], v[120:123], v[240:243], v[40:43]
    v_mfma_f32_16x16x32_bf16 v[44:47], v[124:127], v[240:243], v[44:47]
    v_mfma_f32_16x16x32_bf16 v[48:51], v[128:131], v[240:243], v[48:51]
    buffer_load_dwordx4 v[224:227], v248, s[28:31], s72 offen offset:3072 sc1
    v_mfma_f32_16x16x32_bf16 v[52:55], v[132:135], v[240:243], v[52:55]
    v_mfma_f32_16x16x32_bf16 v[56:59], v[136:139], v[240:243], v[56:59]
    v_mfma_f32_16x16x32_bf16 v[60:63], v[120:123], v[244:247], v[60:63]
    buffer_load_dwordx4 v[228:231], v248, s[28:31], s73 offen sc1
    v_mfma_f32_16x16x32_bf16 v[64:67], v[124:127], v[244:247], v[64:67]
    v_mfma_f32_16x16x32_bf16 v[68:71], v[128:131], v[244:247], v[68:71]
    v_mfma_f32_16x16x32_bf16 v[72:75], v[132:135], v[244:247], v[72:75]
    v_mfma_f32_16x16x32_bf16 v[76:79], v[136:139], v[244:247], v[76:79]
    s_waitcnt vmcnt(9)
    s_waitcnt lgkmcnt(0)
    s_mov_b32 s71, 0
    s_atomic_add s71, s[10:11], s65 glc
    v_mfma_f32_16x16x32_bf16 v[0:3], v[100:103], v[200:203], v[0:3]
    buffer_load_dwordx4 v[232:235], v250, s[24:27], s8 offen sc1
    v_mfma_f32_16x16x32_bf16 v[4:7], v[104:107], v[200:203], v[4:7]
    v_mfma_f32_16x16x32_bf16 v[8:11], v[108:111], v[200:203], v[8:11]
    v_mfma_f32_16x16x32_bf16 v[12:15], v[112:115], v[200:203], v[12:15]
    buffer_load_dwordx4 v[236:239], v251, s[24:27], s8 offen sc1
    v_mfma_f32_16x16x32_bf16 v[16:19], v[116:119], v[200:203], v[16:19]
    v_mfma_f32_16x16x32_bf16 v[20:23], v[100:103], v[204:207], v[20:23]
    v_mfma_f32_16x16x32_bf16 v[24:27], v[104:107], v[204:207], v[24:27]
    buffer_load_dwordx4 v[240:243], v252, s[24:27], s8 offen sc1
    v_mfma_f32_16x16x32_bf16 v[28:31], v[108:111], v[204:207], v[28:31]
    v_mfma_f32_16x16x32_bf16 v[32:35], v[112:115], v[204:207], v[32:35]
    v_mfma_f32_16x16x32_bf16 v[36:39], v[116:119], v[204:207], v[36:39]
    buffer_load_dwordx4 v[244:247], v253, s[24:27], s8 offen sc1
    v_mfma_f32_16x16x32_bf16 v[40:43], v[100:103], v[208:211], v[40:43]
    v_mfma_f32_16x16x32_bf16 v[44:47], v[104:107], v[208:211], v[44:47]
    v_mfma_f32_16x16x32_bf16 v[48:51], v[108:111], v[208:211], v[48:51]
    buffer_load_dwordx4 v[120:123], v250, s[24:27], s9 offen sc1
    v_mfma_f32_16x16x32_bf16 v[52:55], v[112:115], v[208:211], v[52:55]
    v_mfma_f32_16x16x32_bf16 v[56:59], v[116:119], v[208:211], v[56:59]
    v_mfma_f32_16x16x32_bf16 v[60:63], v[100:103], v[212:215], v[60:63]
    buffer_load_dwordx4 v[124:127], v251, s[24:27], s9 offen sc1
    v_mfma_f32_16x16x32_bf16 v[64:67], v[104:107], v[212:215], v[64:67]
    v_mfma_f32_16x16x32_bf16 v[68:71], v[108:111], v[212:215], v[68:71]
    v_mfma_f32_16x16x32_bf16 v[72:75], v[112:115], v[212:215], v[72:75]
    buffer_load_dwordx4 v[128:131], v252, s[24:27], s9 offen sc1
    v_mfma_f32_16x16x32_bf16 v[76:79], v[116:119], v[212:215], v[76:79]
    s_waitcnt vmcnt(12)
    v_mfma_f32_16x16x32_bf16 v[0:3], v[140:143], v[80:83], v[0:3]
    buffer_load_dwordx4 v[132:135], v253, s[24:27], s9 offen sc1
    v_mfma_f32_16x16x32_bf16 v[4:7], v[144:147], v[80:83], v[4:7]
    v_mfma_f32_16x16x32_bf16 v[8:11], v[148:151], v[80:83], v[8:11]
    buffer_load_dwordx4 v[136:139], v250, s[24:27], s12 offen sc1
    v_mfma_f32_16x16x32_bf16 v[12:15], v[152:155], v[80:83], v[12:15]
    buffer_load_dwordx4 v[200:203], v251, s[24:27], s12 offen sc1
    v_mfma_f32_16x16x32_bf16 v[16:19], v[156:159], v[80:83], v[16:19]
    v_mfma_f32_16x16x32_bf16 v[20:23], v[140:143], v[84:87], v[20:23]
    v_mfma_f32_16x16x32_bf16 v[24:27], v[144:147], v[84:87], v[24:27]
    buffer_load_dwordx4 v[204:207], v252, s[24:27], s12 offen sc1
    v_mfma_f32_16x16x32_bf16 v[28:31], v[148:151], v[84:87], v[28:31]
    v_mfma_f32_16x16x32_bf16 v[32:35], v[152:155], v[84:87], v[32:35]
    v_mfma_f32_16x16x32_bf16 v[36:39], v[156:159], v[84:87], v[36:39]
    buffer_load_dwordx4 v[208:211], v253, s[24:27], s12 offen sc1
    v_mfma_f32_16x16x32_bf16 v[40:43], v[140:143], v[88:91], v[40:43]
    v_mfma_f32_16x16x32_bf16 v[44:47], v[144:147], v[88:91], v[44:47]
    v_mfma_f32_16x16x32_bf16 v[48:51], v[148:151], v[88:91], v[48:51]
    buffer_load_dwordx4 v[212:215], v248, s[28:31], s74 offen offset:0 sc1
    v_mfma_f32_16x16x32_bf16 v[52:55], v[152:155], v[88:91], v[52:55]
    v_mfma_f32_16x16x32_bf16 v[56:59], v[156:159], v[88:91], v[56:59]
    v_mfma_f32_16x16x32_bf16 v[60:63], v[140:143], v[92:95], v[60:63]
    buffer_load_dwordx4 v[100:103], v248, s[28:31], s74 offen offset:1024 sc1
    v_mfma_f32_16x16x32_bf16 v[64:67], v[144:147], v[92:95], v[64:67]
    v_mfma_f32_16x16x32_bf16 v[68:71], v[148:151], v[92:95], v[68:71]
    v_mfma_f32_16x16x32_bf16 v[72:75], v[152:155], v[92:95], v[72:75]
    buffer_load_dwordx4 v[104:107], v248, s[28:31], s74 offen offset:2048 sc1
    v_mfma_f32_16x16x32_bf16 v[76:79], v[156:159], v[92:95], v[76:79]
    s_mov_b32 s70, 0
    s_branch sq1_chk
sq1_top:
    s_mov_b32 s71, 0
    s_atomic_add s71, s[10:11], s65 glc
sq1_chk:
    s_waitcnt lgkmcnt(0)
    s_and_b32 s71, s71, s67
    s_cmp_eq_u32 s71, s67
    s_cbranch_scc1 sq1_ok
sq1_no:
    s_sleep 2
    s_add_u32 s70, s70, 1
    s_cmp_lt_u32 s70, 30000
    s_cbranch_scc1 sq1_top
    s_endpgm
sq1_ok:
    s_waitcnt vmcnt(15)
    s_waitcnt vmcnt(11)
    v_mfma_f32_16x16x32_bf16 v[0:3], v[96:99], v[232:235], v[0:3]
    buffer_load_dwordx4 v[108:111], v248, s[28:31], s74 offen offset:3072 sc1
    v_mfma_f32_16x16x32_bf16 v[4:7], v[216:219], v[232:235], v[4:7]
    ds_read_b128 v[92:95], v249 offset:5120
    v_mfma_f32_16x16x32_bf16 v[8:11], v[220:223], v[232:235], v[8:11]
    ds_read_b128 v[140:143], v249 offset:6144
    v_mfma_f32_16x16x32_bf16 v[12:15], v[224:227], v[232:235], v[12:15]
    buffer_load_dwordx4 v[112:115], v248, s[28:31], s75 offen sc1
    v_mfma_f32_16x16x32_bf16 v[16:19], v[228:231], v[232:235], v[16:19]
    ds_read_b128 v[144:147], v249 offset:7168
    v_mfma_f32_16x16x32_bf16 v[20:23], v[96:99], v[236:239], v[20:23]
    ds_read_b128 v[148:151], v249 offset:8192
    v_mfma_f32_16x16x32_bf16 v[24:27], v[216:219], v[236:239], v[24:27]
    buffer_load_dwordx4 v[116:119], v250, s[24:27], s13 offen sc1
    v_mfma_f32_16x16x32_bf16 v[28:31], v[220:223], v[236:239], v[28:31]
    ds_read_b128 v[152:155], v249 offset:9216
    v_mfma_f32_16x16x32_bf16 v[32:35], v[224:227], v[236:239], v[32:35]
    v_mfma_f32_16x16x32_bf16 v[36:39], v[228:231], v[236:239], v[36:39]
    buffer_load_dwordx4 v[80:83], v251, s[24:27], s13 offen sc1
    v_mfma_f32_16x16x32_bf16 v[40:43], v[96:99], v[240:243], v[40:43]
    v_mfma_f32_16x16x32_bf16 v[44:47], v[216:219], v[240:243], v[44:47]
    v_mfma_f32_16x16x32_bf16 v[48:51], v[220:223], v[240:243], v[48:51]
    buffer_load_dwordx4 v[84:87], v252, s[24:27], s13 offen sc1
    v_mfma_f32_16x16x32_bf16 v[52:55], v[224:227], v[240:243], v[52:55]
    v_mfma_f32_16x16x32_bf16 v[56:59], v[228:231], v[240:243], v[56:59]
    v_mfma_f32_16x16x32_bf16 v[60:63], v[96:99], v[244:247], v[60:63]
    buffer_load_dwordx4 v[88:91], v253, s[24:27], s13 offen sc1
    v_mfma_f32_16x16x32_bf16 v[64:67], v[216:219], v[244:247], v[64:67]
    v_mfma_f32_16x16x32_bf16 v[68:71], v[220:223], v[244:247], v[68:71]
    v_mfma_f32_16x16x32_bf16 v[72:75], v[224:227], v[244:247], v[72:75]
    buffer_load_dwordx4 v[156:159], v250, s[24:27], s14 offen sc1
    v_mfma_f32_16x16x32_bf16 v[76:79], v[228:231], v[244:247], v[76:79]
    s_waitcnt vmcnt(14)
    s_waitcnt lgkmcnt(0)
    v_mfma_f32_16x16x32_bf16 v[0:3], v[92:95], v[120:123], v[0:3]
    buffer_load_dwordx4 v[232:235], v251, s[24:27], s14 offen sc1
    v_mfma_f32_16x16x32_bf16 v[4:7], v[140:143], v[120:123], v[4:7]
    v_mfma_f32_16x16x32_bf16 v[8:11], v[144:147], v[120:123], v[8:11]
    v_mfma_f32_16x16x32_bf16 v[12:15], v[148:151], v[120:123], v[12:15]
    buffer_load_dwordx4 v[236:239], v252, s[24:27], s14 offen sc1
    v_mfma_f32_16x16x32_bf16 v[16:19], v[152:155], v[120:123], v[16:19]
    v_mfma_f32_16x16x32_bf16 v[20:23], v[92:95], v[124:127], v[20:23]
    v_mfma_f32_16x16x32_bf16 v[24:27], v[140:143], v[124:127], v[24:27]
    buffer_load_dwordx4 v[240:243], v253, s[24:27], s14 offen sc1
    v_mfma_f32_16x16x32_bf16 v[28:31], v[144:147], v[124:127], v[28:31]
    v_mfma_f32_16x16x32_bf16 v[32:35], v[148:151], v[124:127], v[32:35]
    v_mfma_f32_16x16x32_bf16 v[36:39], v[152:155], v[124:127], v[36:39]
    buffer_load_dwordx4 v[244:247], v250, s[24:27], s15 offen sc1
    v_mfma_f32_16x16x32_bf16 v[40:43], v[92:95], v[128:131], v[40:43]
    v_mfma_f32_16x16x32_bf16 v[44:47], v[140:143], v[128:131], v[44:47]
    v_mfma_f32_16x16x32_bf16 v[48:51], v[144:147], v[128:131], v[48:51]
    buffer_load_dwordx4 v[96:99], v251, s[24:27], s15 offen sc1
    v_mfma_f32_16x16x32_bf16 v[52:55], v[148:151], v[128:131], v[52:55]
    v_mfma_f32_16x16x32_bf16 v[56:59], v[152:155], v[128:131], v[56:59]
    v_mfma_f32_16x16x32_bf16 v[60:63], v[92:95], v[132:135], v[60:63]
    buffer_load_dwordx4 v[216:219], v252, s[24:27], s15 offen sc1
    v_mfma_f32_16x16x32_bf16 v[64:67], v[140:143], v[132:135], v[64:67]
    v_mfma_f32_16x16x32_bf16 v[68:71], v[144:147], v[132:135], v[68:71]
    v_mfma_f32_16x16x32_bf16 v[72:75], v[148:151], v[132:135], v[72:75]
    buffer_load_dwordx4 v[220:223], v253, s[24:27], s15 offen sc1
    v_mfma_f32_16x16x32_bf16 v[76:79], v[152:155], v[132:135], v[76:79]
    s_waitcnt vmcnt(17)
    s_mov_b32 s71, 0
    s_atomic_add s71, s[10:11], s61 glc
    v_mfma_f32_16x16x32_bf16 v[0:3], v[160:163], v[136:139], v[0:3]
    buffer_load_dwordx4 v[224:227], v248, s[28:31], s76 offen offset:0 sc1
    v_mfma_f32_16x16x32_bf16 v[4:7], v[164:167], v[136:139], v[4:7]
    v_mfma_f32_16x16x32_bf16 v[8:11], v[168:171], v[136:139], v[8:11]
    v_mfma_f32_16x16x32_bf16 v[12:15], v[172:175], v[136:139], v[12:15]
    buffer_load_dwordx4 v[228:231], v248, s[28:31], s76 offen offset:1024 sc1
    v_mfma_f32_16x16x32_bf16 v[16:19], v[176:179], v[136:139], v[16:19]
    v_mfma_f32_16x16x32_bf16 v[20:23], v[160:163], v[200:203], v[20:23]
    v_mfma_f32_16x16x32_bf16 v[24:27], v[164:167], v[200:203], v[24:27]
    buffer_load_dwordx4 v[120:123], v248, s[28:31], s76 offen offset:2048 sc1
    v_mfma_f32_16x16x32_bf16 v[28:31], v[168:171], v[200:203], v[28:31]
    v_mfma_f32_16x16x32_bf16 v[32:35], v[172:175], v[200:203], v[32:35]
    v_mfma_f32_16x16x32_bf16 v[36:39], v[176:179], v[200:203], v[36:39]
    buffer_load_dwordx4 v[124:127], v248, s[28:31], s76 offen offset:3072 sc1
    v_mfma_f32_16x16x32_bf16 v[40:43], v[160:163], v[204:207], v[40:43]
    v_mfma_f32_16x16x32_bf16 v[44:47], v[164:167], v[204:207], v[44:47]
    v_mfma_f32_16x16x32_bf16 v[48:51], v[168:171], v[204:207], v[48:51]
    buffer_load_dwordx4 v[128:131], v248, s[28:31], s77 offen sc1
    v_mfma_f32_16x16x32_bf16 v[52:55], v[172:175], v[204:207], v[52:55]
    v_mfma_f32_16x16x32_bf16 v[56:59], v[176:179], v[204:207], v[56:59]
    v_mfma_f32_16x16x32_bf16 v[60:63], v[160:163], v[208:211], v[60:63]
    buffer_load_dwordx4 v[132:135], v250, s[24:27], s16 offen sc1
    v_mfma_f32_16x16x32_bf16 v[64:67], v[164:167], v[208:211], v[64:67]
    v_mfma_f32_16x16x32_bf16 v[68:71], v[168:171], v[208:211], v[68:71]
    v_mfma_f32_16x16x32_bf16 v[72:75], v[172:175], v[208:211], v[72:75]
    buffer_load_dwordx4 v[92:95], v251, s[24:27], s16 offen sc1
    v_mfma_f32_16x16x32_bf16 v[76:79], v[176:179], v[208:211], v[76:79]
    s_waitcnt vmcnt(19)
    s_waitcnt vmcnt(15)
    v_mfma_f32_16x16x32_bf16 v[0:3], v[212:215], v[116:119], v[0:3]
    buffer_load_dwordx4 v[140:143], v252, s[24:27], s16 offen sc1
    v_mfma_f32_16x16x32_bf16 v[4:7], v[100:103], v[116:119], v[4:7]
    ds_read_b128 v[148:151], v249 offset:10240
    v_mfma_f32_16x16x32_bf16 v[8:11], v[104:107], v[116:119], v[8:11]
    ds_read_b128 v[152:155], v249 offset:11264
    v_mfma_f32_16x16x32_bf16 v[12:15], v[108:111], v[116:119], v[12:15]
    buffer_load_dwordx4 v[144:147], v253, s[24:27], s16 offen sc1
    v_mfma_f32_16x16x32_bf16 v[16:19], v[112:115], v[116:119], v[16:19]
    ds_read_b128 v[136:139], v249 offset:12288
    v_mfma_f32_16x16x32_bf16 v[20:23], v[212:215], v[80:83], v[20:23]
    ds_read_b128 v[200:203], v249 offset:13312
    v_mfma_f32_16x16x32_bf16 v[24:27], v[100:103], v[80:83], v[24:27]
    ds_read_b128 v[204:207], v249 offset:14336
    v_mfma_f32_16x16x32_bf16 v[28:31], v[104:107], v[80:83], v[28:31]
    v_mfma_f32_16x16x32_bf16 v[32:35], v[108:111], v[80:83], v[32:35]
    v_mfma_f32_16x16x32_bf16 v[36:39], v[112:115], v[80:83], v[36:39]
    v_mfma_f32_16x16x32_bf16 v[40:43], v[212:215], v[84:87], v[40:43]
    v_mfma_f32_16x16x32_bf16 v[44:47], v[100:103], v[84:87], v[44:47]
    v_mfma_f32_16x16x32_bf16 v[48:51], v[104:107], v[84:87], v[48:51]
    v_mfma_f32_16x16x32_bf16 v[52:55], v[108:111], v[84:87], v[52:55]
    v_mfma_f32_16x16x32_bf16 v[56:59], v[112:115], v[84:87], v[56:59]
    v_mfma_f32_16x16x32_bf16 v[60:63], v[212:215], v[88:91], v[60:63]
    v_mfma_f32_16x16x32_bf16 v[64:67], v[100:103], v[88:91], v[64:67]
    v_mfma_f32_16x16x32_bf16 v[68:71], v[104:107], v[88:91], v[68:71]
    v_mfma_f32_16x16x32_bf16 v[72:75], v[108:111], v[88:91], v[72:75]
    v_mfma_f32_16x16x32_bf16 v[76:79], v[112:115], v[88:91], v[76:79]
    s_mov_b32 s70, 0
    s_branch sq2_chk
sq2_top:
    s_mov_b32 s71, 0
    s_atomic_add s71, s[10:11], s61 glc
sq2_chk:
    s_waitcnt lgkmcnt(0)
    s_and_b32 s71, s71, s66
    s_cmp_eq_u32 s71, s66
    s_cbranch_scc1 sq2_ok
sq2_no:
    s_sleep 2
    s_add_u32 s70, s70, 1
    s_cmp_lt_u32 s70, 30000
    s_cbranch_scc1 sq2_top
    s_endpgm
sq2_ok:
    s_waitcnt vmcnt(13)
    s_waitcnt lgkmcnt(0)
    v_mfma_f32_16x16x32_bf16 v[0:3], v[148:151], v[156:159], v[0:3]
    buffer_load_dwordx4 v[208:211], v250, s[24:27], s17 offen sc1
    v_mfma_f32_16x16x32_bf16 v[4:7], v[152:155], v[156:159], v[4:7]
    v_mfma_f32_16x16x32_bf16 v[8:11], v[136:139], v[156:159], v[8:11]
    v_mfma_f32_16x16x32_bf16 v[12:15], v[200:203], v[156:159], v[12:15]
    buffer_load_dwordx4 v[160:163], v251, s[24:27], s17 offen sc1
    v_mfma_f32_16x16x32_bf16 v[16:19], v[204:207], v[156:159], v[16:19]
    v_mfma_f32_16x16x32_bf16 v[20:23], v[148:151], v[232:235], v[20:23]
    v_mfma_f32_16x16x32_bf16 v[24:27], v[152:155], v[232:235], v[24:27]
    buffer_load_dwordx4 v[164:167], v252, s[24:27], s17 offen sc1
    v_mfma_f32_16x16x32_bf16 v[28:31], v[136:139], v[232:235], v[28:31]
    v_mfma_f32_16x16x32_bf16 v[32:35], v[200:203], v[232:235], v[32:35]
    v_mfma_f32_16x16x32_bf16 v[36:39], v[204:207], v[232:235], v[36:39]
    buffer_load_dwordx4 v[168:171], v253, s[24:27], s17 offen sc1
    v_mfma_f32_16x16x32_bf16 v[40:43], v[148:151], v[236:239], v[40:43]
    v_mfma_f32_16x16x32_bf16 v[44:47], v[152:155], v[236:239], v[44:47]
    v_mfma_f32_16x16x32_bf16 v[48:51], v[136:139], v[236:239], v[48:51]
    buffer_load_dwordx4 v[172:175], v250, s[24:27], s18 offen sc1
    v_mfma_f32_16x16x32_bf16 v[52:55], v[200:203], v[236:239], v[52:55]
    v_mfma_f32_16x16x32_bf16 v[56:59], v[204:207], v[236:239], v[56:59]
    v_mfma_f32_16x16x32_bf16 v[60:63], v[148:151], v[240:243], v[60:63]
    buffer_load_dwordx4 v[176:179], v251, s[24:27], s18 offen sc1
    v_mfma_f32_16x16x32_bf16 v[64:67], v[152:155], v[240:243], v[64:67]
    v_mfma_f32_16x16x32_bf16 v[68:71], v[136:139], v[240:243], v[68:71]
    v_mfma_f32_16x16x32_bf16 v[72:75], v[200:203], v[240:243], v[72:75]
    buffer_load_dwordx4 v[116:119], v252, s[24:27], s18 offen sc1
    v_mfma_f32_16x16x32_bf16 v[76:79], v[204:207], v[240:243], v[76:79]
    s_waitcnt vmcnt(16)
    v_mfma_f32_16x16x32_bf16 v[0:3], v[180:183], v[244:247], v[0:3]
    buffer_load_dwordx4 v[80:83], v253, s[24:27], s18 offen sc1
    v_mfma_f32_16x16x32_bf16 v[4:7], v[184:187], v[244:247], v[4:7]
    v_mfma_f32_16x16x32_bf16 v[8:11], v[188:191], v[244:247], v[8:11]
    buffer_load_dwordx4 v[84:87], v254, s[32:35], 0 offen
    v_mfma_f32_16x16x32_bf16 v[12:15], v[192:195], v[244:247], v[12:15]
    v_mfma_f32_16x16x32_bf16 v[16:19], v[196:199], v[244:247], v[16:19]
    buffer_load_dwordx4 v[88:91], v254, s[32:35], 0 offen offset:64
    v_mfma_f32_16x16x32_bf16 v[20:23], v[180:183], v[96:99], v[20:23]
    v_mfma_f32_16x16x32_bf16 v[24:27], v[184:187], v[96:99], v[24:27]
    buffer_load_dwordx2 v[212:213], v255, s[32:35], 0 offen offset:128
    v_mfma_f32_16x16x32_bf16 v[28:31], v[188:191], v[96:99], v[28:31]
    v_mfma_f32_16x16x32_bf16 v[32:35], v[192:195], v[96:99], v[32:35]
    buffer_load_dwordx4 v[100:103], v248, s[28:31], s78 offen offset:0 sc1
    v_mfma_f32_16x16x32_bf16 v[36:39], v[196:199], v[96:99], v[36:39]
    buffer_load_dwordx4 v[104:107], v248, s[28:31], s78 offen offset:1024 sc1
    v_mfma_f32_16x16x32_bf16 v[40:43], v[180:183], v[216:219], v[40:43]
    v_mfma_f32_16x16x32_bf16 v[44:47], v[184:187], v[216:219], v[44:47]
    v_mfma_f32_16x16x32_bf16 v[48:51], v[188:191], v[216:219], v[48:51]
    buffer_load_dwordx4 v[108:111], v248, s[28:31], s78 offen offset:2048 sc1
    v_mfma_f32_16x16x32_bf16 v[52:55], v[192:195], v[216:219], v[52:55]
    v_mfma_f32_16x16x32_bf16 v[56:59], v[196:199], v[216:219], v[56:59]
    v_mfma_f32_16x16x32_bf16 v[60:63], v[180:183], v[220:223], v[60:63]
    buffer_load_dwordx4 v[112:115], v248, s[28:31], s78 offen offset:3072 sc1
    v_mfma_f32_16x16x32_bf16 v[64:67], v[184:187], v[220:223], v[64:67]
    v_mfma_f32_16x16x32_bf16 v[68:71], v[188:191], v[220:223], v[68:71]
    v_mfma_f32_16x16x32_bf16 v[72:75], v[192:195], v[220:223], v[72:75]
    buffer_load_dwordx4 v[156:159], v248, s[28:31], s79 offen sc1
    v_mfma_f32_16x16x32_bf16 v[76:79], v[196:199], v[220:223], v[76:79]
    s_waitcnt vmcnt(20)
    s_waitcnt vmcnt(16)
    v_mfma_f32_16x16x32_bf16 v[0:3], v[224:227], v[132:135], v[0:3]
    buffer_load_dwordx4 v[232:235], v250, s[24:27], s19 offen sc1
    v_mfma_f32_16x16x32_bf16 v[4:7], v[228:231], v[132:135], v[4:7]
    ds_read_b128 v[244:247], v249 offset:15360
    v_mfma_f32_16x16x32_bf16 v[8:11], v[120:123], v[132:135], v[8:11]
    ds_read_b128 v[96:99], v249 offset:16384
    v_mfma_f32_16x16x32_bf16 v[12:15], v[124:127], v[132:135], v[12:15]
    buffer_load_dwordx4 v[236:239], v251, s[24:27], s19 offen sc1
    v_mfma_f32_16x16x32_bf16 v[16:19], v[128:131], v[132:135], v[16:19]
    ds_read_b128 v[216:219], v249 offset:17408
    v_mfma_f32_16x16x32_bf16 v[20:23], v[224:227], v[92:95], v[20:23]
    ds_read_b128 v[220:223], v249 offset:18432
    v_mfma_f32_16x16x32_bf16 v[24:27], v[228:231], v[92:95], v[24:27]
    buffer_load_dwordx4 v[240:243], v252, s[24:27], s19 offen sc1
    v_mfma_f32_16x16x32_bf16 v[28:31], v[120:123], v[92:95], v[28:31]
    ds_read_b128 v[180:183], v249 offset:19456
    v_mfma_f32_16x16x32_bf16 v[32:35], v[124:127], v[92:95], v[32:35]
    v_mfma_f32_16x16x32_bf16 v[36:39], v[128:131], v[92:95], v[36:39]
    buffer_load_dwordx4 v[148:151], v253, s[24:27], s19 offen sc1
    v_mfma_f32_16x16x32_bf16 v[40:43], v[224:227], v[140:143], v[40:43]
    v_mfma_f32_16x16x32_bf16 v[44:47], v[228:231], v[140:143], v[44:47]
    v_mfma_f32_16x16x32_bf16 v[48:51], v[120:123], v[140:143], v[48:51]
    buffer_load_dwordx4 v[152:155], v250, s[24:27], s20 offen sc1
    v_mfma_f32_16x16x32_bf16 v[52:55], v[124:127], v[140:143], v[52:55]
    v_mfma_f32_16x16x32_bf16 v[56:59], v[128:131], v[140:143], v[56:59]
    v_mfma_f32_16x16x32_bf16 v[60:63], v[224:227], v[144:147], v[60:63]
    buffer_load_dwordx4 v[136:139], v251, s[24:27], s20 offen sc1
    v_mfma_f32_16x16x32_bf16 v[64:67], v[228:231], v[144:147], v[64:67]
    v_mfma_f32_16x16x32_bf16 v[68:71], v[120:123], v[144:147], v[68:71]
    v_mfma_f32_16x16x32_bf16 v[72:75], v[124:127], v[144:147], v[72:75]
    buffer_load_dwordx4 v[200:203], v252, s[24:27], s20 offen sc1
    v_mfma_f32_16x16x32_bf16 v[76:79], v[128:131], v[144:147], v[76:79]
    s_waitcnt vmcnt(19)
    s_waitcnt lgkmcnt(0)
    v_mfma_f32_16x16x32_bf16 v[0:3], v[244:247], v[208:211], v[0:3]
    buffer_load_dwordx4 v[204:207], v253, s[24:27], s20 offen sc1
    v_mfma_f32_16x16x32_bf16 v[4:7], v[96:99], v[208:211], v[4:7]
    ds_read_b128 v[224:227], v249 offset:20480
    v_mfma_f32_16x16x32_bf16 v[8:11], v[216:219], v[208:211], v[8:11]
    ds_read_b128 v[228:231], v249 offset:21504
    v_mfma_f32_16x16x32_bf16 v[12:15], v[220:223], v[208:211], v[12:15]
    v_lshrrev_b32 v184, 5, v248
    v_and_b32 v250, 0xc00, v250
    v_lshl_add_u32 v250, v184, 4, v250
    buffer_load_dwordx4 v[184:187], v250, s[24:27], s21 offen sc1
    v_mfma_f32_16x16x32_bf16 v[16:19], v[180:183], v[208:211], v[16:19]
    ds_read_b128 v[120:123], v249 offset:22528
    v_mfma_f32_16x16x32_bf16 v[20:23], v[244:247], v[160:163], v[20:23]
    ds_read_b128 v[124:127], v249 offset:23552
    v_mfma_f32_16x16x32_bf16 v[24:27], v[96:99], v[160:163], v[24:27]
    buffer_load_dwordx4 v[132:135], v250, s[24:27], s21 offen offset:512 sc1
    v_mfma_f32_16x16x32_bf16 v[28:31], v[216:219], v[160:163], v[28:31]
    ds_read_b128 v[128:131], v249 offset:24576
    v_mfma_f32_16x16x32_bf16 v[32:35], v[220:223], v[160:163], v[32:35]
    v_mfma_f32_16x16x32_bf16 v[36:39], v[180:183], v[160:163], v[36:39]
    v_lshrrev_b32 v188, 5, v248
    v_and_b32 v251, 0xc00, v251
    v_lshl_add_u32 v251, v188, 4, v251
    buffer_load_dwordx4 v[188:191], v251, s[24:27], s21 offen sc1
    v_mfma_f32_16x16x32_bf16 v[40:43], v[244:247], v[164:167], v[40:43]
    v_mfma_f32_16x16x32_bf16 v[44:47], v[96:99], v[164:167], v[44:47]
    v_mfma_f32_16x16x32_bf16 v[48:51], v[216:219], v[164:167], v[48:51]
    buffer_load_dwordx4 v[92:95], v251, s[24:27], s21 offen offset:512 sc1
    v_mfma_f32_16x16x32_bf16 v[52:55], v[220:223], v[164:167], v[52:55]
    v_mfma_f32_16x16x32_bf16 v[56:59], v[180:183], v[164:167], v[56:59]
    v_mfma_f32_16x16x32_bf16 v[60:63], v[244:247], v[168:171], v[60:63]
    v_lshrrev_b32 v192, 5, v248
    v_and_b32 v252, 0xc00, v252
    v_lshl_add_u32 v252, v192, 4, v252
    buffer_load_dwordx4 v[192:195], v252, s[24:27], s21 offen sc1
    v_mfma_f32_16x16x32_bf16 v[64:67], v[96:99], v[168:171], v[64:67]
    v_mfma_f32_16x16x32_bf16 v[68:71], v[216:219], v[168:171], v[68:71]
    v_mfma_f32_16x16x32_bf16 v[72:75], v[220:223], v[168:171], v[72:75]
    buffer_load_dwordx4 v[140:143], v252, s[24:27], s21 offen offset:512 sc1
    v_mfma_f32_16x16x32_bf16 v[76:79], v[180:183], v[168:171], v[76:79]
    s_waitcnt vmcnt(22)
    s_waitcnt lgkmcnt(0)
    v_mfma_f32_16x16x32_bf16 v[0:3], v[224:227], v[172:175], v[0:3]
    v_lshrrev_b32 v196, 5, v248
    v_and_b32 v253, 0xc00, v253
    v_lshl_add_u32 v253, v196, 4, v253
    buffer_load_dwordx4 v[196:199], v253, s[24:27], s21 offen sc1
    v_mfma_f32_16x16x32_bf16 v[4:7], v[228:231], v[172:175], v[4:7]
    v_mfma_f32_16x16x32_bf16 v[8:11], v[120:123], v[172:175], v[8:11]
    v_mfma_f32_16x16x32_bf16 v[12:15], v[124:127], v[172:175], v[12:15]
    buffer_load_dwordx4 v[144:147], v253, s[24:27], s21 offen offset:512 sc1
    v_mfma_f32_16x16x32_bf16 v[16:19], v[128:131], v[172:175], v[16:19]
    v_mfma_f32_16x16x32_bf16 v[20:23], v[224:227], v[176:179], v[20:23]
    v_mfma_f32_16x16x32_bf16 v[24:27], v[228:231], v[176:179], v[24:27]
    v_mfma_f32_16x16x32_bf16 v[28:31], v[120:123], v[176:179], v[28:31]
    v_mfma_f32_16x16x32_bf16 v[32:35], v[124:127], v[176:179], v[32:35]
    v_mfma_f32_16x16x32_bf16 v[36:39], v[128:131], v[176:179], v[36:39]
    v_mfma_f32_16x16x32_bf16 v[40:43], v[224:227], v[116:119], v[40:43]
    v_mfma_f32_16x16x32_bf16 v[44:47], v[228:231], v[116:119], v[44:47]
    v_mfma_f32_16x16x32_bf16 v[48:51], v[120:123], v[116:119], v[48:51]
    v_mfma_f32_16x16x32_bf16 v[52:55], v[124:127], v[116:119], v[52:55]
    v_mfma_f32_16x16x32_bf16 v[56:59], v[128:131], v[116:119], v[56:59]
    v_mfma_f32_16x16x32_bf16 v[60:63], v[224:227], v[80:83], v[60:63]
    v_mfma_f32_16x16x32_bf16 v[64:67], v[228:231], v[80:83], v[64:67]
    v_mfma_f32_16x16x32_bf16 v[68:71], v[120:123], v[80:83], v[68:71]
    v_mfma_f32_16x16x32_bf16 v[72:75], v[124:127], v[80:83], v[72:75]
    v_mfma_f32_16x16x32_bf16 v[76:79], v[128:131], v[80:83], v[76:79]
    s_waitcnt vmcnt(16)
    s_waitcnt vmcnt(12)
    v_mfma_f32_16x16x32_bf16 v[0:3], v[100:103], v[232:235], v[0:3]
    ds_read_b128 v[208:211], v249 offset:25600
    v_mfma_f32_16x16x32_bf16 v[4:7], v[104:107], v[232:235], v[4:7]
    ds_read_b128 v[160:163], v249 offset:26624
    v_mfma_f32_16x16x32_bf16 v[8:11], v[108:111], v[232:235], v[8:11]
    ds_read_b128 v[164:167], v249 offset:27648
    v_mfma_f32_16x16x32_bf16 v[12:15], v[112:115], v[232:235], v[12:15]
    ds_read_b128 v[168:171], v249 offset:28672
    v_mfma_f32_16x16x32_bf16 v[16:19], v[156:159], v[232:235], v[16:19]
    ds_read_b128 v[244:247], v249 offset:29696
    v_mfma_f32_16x16x32_bf16 v[20:23], v[100:103], v[236:239], v[20:23]
    v_mfma_f32_16x16x32_bf16 v[24:27], v[104:107], v[236:239], v[24:27]
    v_mfma_f32_16x16x32_bf16 v[28:31], v[108:111], v[236:239], v[28:31]
    v_mfma_f32_16x16x32_bf16 v[32:35], v[112:115], v[236:239], v[32:35]
    v_mfma_f32_16x16x32_bf16 v[36:39], v[156:159], v[236:239], v[36:39]
    v_mfma_f32_16x16x32_bf16 v[40:43], v[100:103], v[240:243], v[40:43]
    v_mfma_f32_16x16x32_bf16 v[44:47], v[104:107], v[240:243], v[44:47]
    v_mfma_f32_16x16x32_bf16 v[48:51], v[108:111], v[240:243], v[48:51]
    v_mfma_f32_16x16x32_bf16 v[52:55], v[112:115], v[240:243], v[52:55]
    v_mfma_f32_16x16x32_bf16 v[56:59], v[156:159], v[240:243], v[56:59]
    v_mfma_f32_16x16x32_bf16 v[60:63], v[100:103], v[148:151], v[60:63]
    v_mfma_f32_16x16x32_bf16 v[64:67], v[104:107], v[148:151], v[64:67]
    v_mfma_f32_16x16x32_bf16 v[68:71], v[108:111], v[148:151], v[68:71]
    v_mfma_f32_16x16x32_bf16 v[72:75], v[112:115], v[148:151], v[72:75]
    v_mfma_f32_16x16x32_bf16 v[76:79], v[156:159], v[148:151], v[76:79]
    s_waitcnt vmcnt(8)
    s_waitcnt lgkmcnt(0)
    v_mfma_f32_16x16x32_bf16 v[0:3], v[208:211], v[152:155], v[0:3]
    ds_read_b128 v[176:179], v249 offset:30720
    v_lshlrev_b32 v96, 16, v84
    v_mfma_f32_16x16x32_bf16 v[4:7], v[160:163], v[152:155], v[4:7]
    ds_read_b128 v[116:119], v249 offset:31744
    v_and_b32 v97, 0xffff0000, v84
    v_mfma_f32_16x16x32_bf16 v[8:11], v[164:167], v[152:155], v[8:11]
    ds_read_b128 v[80:83], v249 offset:32768
    v_lshlrev_b32 v98, 16, v85
    v_mfma_f32_16x16x32_bf16 v[12:15], v[168:171], v[152:155], v[12:15]
    ds_read_b128 v[224:227], v249 offset:33792
    v_and_b32 v99, 0xffff0000, v85
    v_mfma_f32_16x16x32_bf16 v[16:19], v[244:247], v[152:155], v[16:19]
    ds_read_b128 v[228:231], v249 offset:34816
    v_lshlrev_b32 v216, 16, v86
    v_mfma_f32_16x16x32_bf16 v[20:23], v[208:211], v[136:139], v[20:23]
    v_and_b32 v217, 0xffff0000, v86
    v_mfma_f32_16x16x32_bf16 v[24:27], v[160:163], v[136:139], v[24:27]
    v_lshlrev_b32 v218, 16, v87
    v_mfma_f32_16x16x32_bf16 v[28:31], v[164:167], v[136:139], v[28:31]
    v_and_b32 v219, 0xffff0000, v87
    v_mfma_f32_16x16x32_bf16 v[32:35], v[168:171], v[136:139], v[32:35]
    v_lshlrev_b32 v220, 16, v88
    v_mfma_f32_16x16x32_bf16 v[36:39], v[244:247], v[136:139], v[36:39]
    v_and_b32 v221, 0xffff0000, v88
    v_mfma_f32_16x16x32_bf16 v[40:43], v[208:211], v[200:203], v[40:43]
    v_lshlrev_b32 v222, 16, v89
    v_mfma_f32_16x16x32_bf16 v[44:47], v[160:163], v[200:203], v[44:47]
    v_and_b32 v223, 0xffff0000, v89
    v_mfma_f32_16x16x32_bf16 v[48:51], v[164:167], v[200:203], v[48:51]
    v_lshlrev_b32 v180, 16, v90
    v_mfma_f32_16x16x32_bf16 v[52:55], v[168:171], v[200:203], v[52:55]
    v_and_b32 v181, 0xffff0000, v90
    v_mfma_f32_16x16x32_bf16 v[56:59], v[244:247], v[200:203], v[56:59]
    v_lshlrev_b32 v182, 16, v91
    v_mfma_f32_16x16x32_bf16 v[60:63], v[208:211], v[204:207], v[60:63]
    v_and_b32 v183, 0xffff0000, v91
    v_mfma_f32_16x16x32_bf16 v[64:67], v[160:163], v[204:207], v[64:67]
    v_lshlrev_b32 v172, 16, v212
    v_mfma_f32_16x16x32_bf16 v[68:71], v[164:167], v[204:207], v[68:71]
    v_and_b32 v173, 0xffff0000, v212
    v_mfma_f32_16x16x32_bf16 v[72:75], v[168:171], v[204:207], v[72:75]
    v_lshlrev_b32 v174, 16, v213
    v_mfma_f32_16x16x32_bf16 v[76:79], v[244:247], v[204:207], v[76:79]
    v_and_b32 v175, 0xffff0000, v213
    s_waitcnt vmcnt(0)
    v_cndmask_b32 v188, v188, v190, s[68:69]
    v_cndmask_b32 v189, v189, v191, s[68:69]
    v_cndmask_b32 v190, v92, v94, s[68:69]
    v_cndmask_b32 v191, v93, v95, s[68:69]
    s_sub_u32 s58, s40, 1
    s_and_b32 s58, s58, 3
    s_mul_i32 s58, s58, 35840
    s_sub_u32 s59, s40, 2
    s_and_b32 s59, s59, 3
    s_mul_i32 s59, s59, 35840
    s_sub_u32 s60, s40, 3
    s_and_b32 s60, s60, 3
    s_mul_i32 s60, s60, 35840
    s_waitcnt lgkmcnt(0)
    v_mfma_f32_16x16x32_bf16 v[20:23], v[176:179], v[188:191], v[20:23]
    v_cndmask_b32 v192, v192, v194, s[68:69]
    v_cndmask_b32 v193, v193, v195, s[68:69]
    v_mfma_f32_16x16x32_bf16 v[24:27], v[116:119], v[188:191], v[24:27]
    v_cndmask_b32 v194, v140, v142, s[68:69]
    v_cndmask_b32 v195, v141, v143, s[68:69]
    v_mfma_f32_16x16x32_bf16 v[28:31], v[80:83], v[188:191], v[28:31]
    v_cndmask_b32 v196, v196, v198, s[68:69]
    v_cndmask_b32 v197, v197, v199, s[68:69]
    v_mfma_f32_16x16x32_bf16 v[32:35], v[224:227], v[188:191], v[32:35]
    v_cndmask_b32 v198, v144, v146, s[68:69]
    v_cndmask_b32 v199, v145, v147, s[68:69]
    v_mfma_f32_16x16x32_bf16 v[36:39], v[228:231], v[188:191], v[36:39]
    v_cndmask_b32 v184, v184, v186, s[68:69]
    v_cndmask_b32 v185, v185, v187, s[68:69]
    v_mfma_f32_16x16x32_bf16 v[40:43], v[176:179], v[192:195], v[40:43]
    v_cndmask_b32 v186, v132, v134, s[68:69]
    v_cndmask_b32 v187, v133, v135, s[68:69]
    v_mfma_f32_16x16x32_bf16 v[44:47], v[116:119], v[192:195], v[44:47]
    v_add_u32 v250, s58, v248
    v_add_u32 v251, s59, v248
    v_add_u32 v252, s60, v248
    ds_write_b128 v249, v[20:23] offset:0
    v_mfma_f32_16x16x32_bf16 v[48:51], v[80:83], v[192:195], v[48:51]
    ds_write_b128 v249, v[24:27] offset:1024
    v_mfma_f32_16x16x32_bf16 v[52:55], v[224:227], v[192:195], v[52:55]
    ds_write_b128 v249, v[28:31] offset:2048
    v_mfma_f32_16x16x32_bf16 v[56:59], v[228:231], v[192:195], v[56:59]
    ds_write_b128 v249, v[32:35] offset:3072
    v_mfma_f32_16x16x32_bf16 v[60:63], v[176:179], v[196:199], v[60:63]
    ds_write_b128 v249, v[36:39] offset:4096
    v_mfma_f32_16x16x32_bf16 v[64:67], v[116:119], v[196:199], v[64:67]
    ds_write_b128 v249, v[40:43] offset:5120
    v_mfma_f32_16x16x32_bf16 v[68:71], v[80:83], v[196:199], v[68:71]
    ds_write_b128 v249, v[44:47] offset:6144
    v_mfma_f32_16x16x32_bf16 v[72:75], v[224:227], v[196:199], v[72:75]
    ds_write_b128 v249, v[48:51] offset:7168
    v_mfma_f32_16x16x32_bf16 v[76:79], v[228:231], v[196:199], v[76:79]
    ds_write_b128 v249, v[52:55] offset:8192
    v_mfma_f32_16x16x32_bf16 v[0:3], v[176:179], v[184:187], v[0:3]
    ds_write_b128 v249, v[56:59] offset:9216
    v_mfma_f32_16x16x32_bf16 v[4:7], v[116:119], v[184:187], v[4:7]
    ds_write_b128 v249, v[60:63] offset:10240
    v_mfma_f32_16x16x32_bf16 v[8:11], v[80:83], v[184:187], v[8:11]
    ds_write_b128 v249, v[64:67] offset:11264
    v_mfma_f32_16x16x32_bf16 v[12:15], v[224:227], v[184:187], v[12:15]
    ds_write_b128 v249, v[68:71] offset:12288
    v_mfma_f32_16x16x32_bf16 v[16:19], v[228:231], v[184:187], v[16:19]
    ds_write_b128 v249, v[72:75] offset:13312
    ds_write_b128 v249, v[76:79] offset:14336
    s_waitcnt lgkmcnt(0)
    s_barrier
    ds_read_b128 v[120:123], v250 offset:0
    ds_read_b128 v[124:127], v250 offset:1024
    ds_read_b128 v[240:243], v251 offset:5120
    ds_read_b128 v[148:151], v251 offset:6144
    ds_read_b128 v[112:115], v252 offset:10240
    ds_read_b128 v[156:159], v252 offset:11264
    ds_read_b128 v[128:131], v250 offset:2048
    ds_read_b128 v[232:235], v250 offset:3072
    ds_read_b128 v[100:103], v251 offset:7168
    ds_read_b128 v[104:107], v251 offset:8192
    ds_read_b128 v[152:155], v252 offset:12288
    ds_read_b128 v[136:139], v252 offset:13312
    ds_read_b128 v[236:239], v250 offset:4096
    ds_read_b128 v[108:111], v251 offset:9216
    ds_read_b128 v[200:203], v252 offset:14336
    v_pk_add_f32 v[0:1], v[0:1], v[96:97]
    v_pk_add_f32 v[2:3], v[2:3], v[98:99]
    v_pk_add_f32 v[4:5], v[4:5], v[216:217]
    v_pk_add_f32 v[6:7], v[6:7], v[218:219]
    v_pk_add_f32 v[8:9], v[8:9], v[220:221]
    v_pk_add_f32 v[10:11], v[10:11], v[222:223]
    v_pk_add_f32 v[12:13], v[12:13], v[180:181]
    v_pk_add_f32 v[14:15], v[14:15], v[182:183]
    v_pk_add_f32 v[16:17], v[16:17], v[172:173]
    v_pk_add_f32 v[18:19], v[18:19], v[174:175]
    s_waitcnt lgkmcnt(13)
    v_pk_add_f32 v[0:1], v[0:1], v[120:121]
    v_pk_add_f32 v[2:3], v[2:3], v[122:123]
    v_pk_add_f32 v[4:5], v[4:5], v[124:125]
    v_pk_add_f32 v[6:7], v[6:7], v[126:127]
    s_waitcnt lgkmcnt(11)
    v_pk_add_f32 v[0:1], v[0:1], v[240:241]
    v_pk_add_f32 v[2:3], v[2:3], v[242:243]
    v_pk_add_f32 v[4:5], v[4:5], v[148:149]
    v_pk_add_f32 v[6:7], v[6:7], v[150:151]
    s_waitcnt lgkmcnt(9)
    v_pk_add_f32 v[0:1], v[0:1], v[112:113]
    v_pk_add_f32 v[2:3], v[2:3], v[114:115]
    v_pk_add_f32 v[4:5], v[4:5], v[156:157]
    v_pk_add_f32 v[6:7], v[6:7], v[158:159]
    v_cvt_pk_bf16_f32 v40, v0, v1
    v_cvt_pk_bf16_f32 v41, v2, v3
    v_cvt_pk_bf16_f32 v42, v4, v5
    v_cvt_pk_bf16_f32 v43, v6, v7
    buffer_store_dwordx4 v[40:43], v254, s[36:39], 0 offen offset:0
    s_waitcnt lgkmcnt(7)
    v_pk_add_f32 v[8:9], v[8:9], v[128:129]
    v_pk_add_f32 v[10:11], v[10:11], v[130:131]
    v_pk_add_f32 v[12:13], v[12:13], v[232:233]
    v_pk_add_f32 v[14:15], v[14:15], v[234:235]
    s_waitcnt lgkmcnt(5)
    v_pk_add_f32 v[8:9], v[8:9], v[100:101]
    v_pk_add_f32 v[10:11], v[10:11], v[102:103]
    v_pk_add_f32 v[12:13], v[12:13], v[104:105]
    v_pk_add_f32 v[14:15], v[14:15], v[106:107]
    s_waitcnt lgkmcnt(3)
    v_pk_add_f32 v[8:9], v[8:9], v[152:153]
    v_pk_add_f32 v[10:11], v[10:11], v[154:155]
    v_pk_add_f32 v[12:13], v[12:13], v[136:137]
    v_pk_add_f32 v[14:15], v[14:15], v[138:139]
    v_cvt_pk_bf16_f32 v44, v8, v9
    v_cvt_pk_bf16_f32 v45, v10, v11
    v_cvt_pk_bf16_f32 v46, v12, v13
    v_cvt_pk_bf16_f32 v47, v14, v15
    buffer_store_dwordx4 v[44:47], v254, s[36:39], 0 offen offset:64
    s_waitcnt lgkmcnt(2)
    v_pk_add_f32 v[16:17], v[16:17], v[236:237]
    v_pk_add_f32 v[18:19], v[18:19], v[238:239]
    s_waitcnt lgkmcnt(1)
    v_pk_add_f32 v[16:17], v[16:17], v[108:109]
    v_pk_add_f32 v[18:19], v[18:19], v[110:111]
    s_waitcnt lgkmcnt(0)
    v_pk_add_f32 v[16:17], v[16:17], v[200:201]
    v_pk_add_f32 v[18:19], v[18:19], v[202:203]
    v_cvt_pk_bf16_f32 v48, v16, v17
    v_cvt_pk_bf16_f32 v49, v18, v19
    buffer_store_dwordx2 v[48:49], v255, s[36:39], 0 offen offset:128
    s_endpgm
k_serv:
    s_and_b32 s50, s2, 7
    s_lshl_b32 s51, s50, 5
    s_lshr_b32 s46, s2, 3
    s_add_u32 s51, s51, s46
    s_lshl_b32 s52, s51, 3
    v_lshrrev_b32 v1, 4, v243
    v_and_b32 v2, 15, v243
    v_add_u32 v1, s52, v1
    s_movk_i32 s53, 1280
    v_lshlrev_b32 v3, 4, v2
    v_mad_u32_u24 v3, v1, s53, v3
    v_mov_b32 v30, 0
    s_waitcnt lgkmcnt(0)
    s_mov_b32 s24, s4
    s_mov_b32 s25, s5
    s_mov_b32 s26, 2621440
    s_mov_b32 s27, 0x20000
    s_add_u32 s10, s22, 21037056
    s_addc_u32 s11, s23, 0
    s_movk_i32 s54, 5120
    buffer_load_dwordx4 v[140:143], v3, s[24:27], 0 offen offset:0
    buffer_load_dwordx4 v[144:147], v3, s[24:27], 0 offen offset:256
    buffer_load_dwordx4 v[148:151], v3, s[24:27], 0 offen offset:512
    buffer_load_dwordx4 v[152:155], v3, s[24:27], 0 offen offset:768
    buffer_load_dwordx4 v[156:159], v3, s[24:27], 0 offen offset:1024
    buffer_load_dwordx4 v[160:163], v3, s[24:27], s54 offen offset:0
    buffer_load_dwordx4 v[164:167], v3, s[24:27], s54 offen offset:256
    buffer_load_dwordx4 v[168:171], v3, s[24:27], s54 offen offset:512
    buffer_load_dwordx4 v[172:175], v3, s[24:27], s54 offen offset:768
    buffer_load_dwordx4 v[176:179], v3, s[24:27], s54 offen offset:1024
    s_cmp_lg_u32 s2, 0
    s_cbranch_scc1 sv_ni
    v_mul_u32_u24 v4, 256, v243
    global_store_dword v4, v30, s[10:11] sc1
    global_store_dword v4, v30, s[10:11] offset:128 sc1
    v_add_u32 v4, 16384, v4
    global_store_dword v4, v30, s[10:11] sc1
    global_store_dword v4, v30, s[10:11] offset:128 sc1
    v_add_u32 v4, 16384, v4
    global_store_dword v4, v30, s[10:11] sc1
    global_store_dword v4, v30, s[10:11] offset:128 sc1
    v_add_u32 v4, 16384, v4
sv_ni:
    s_mul_i32 s55, s50, 160
    v_add_u32 v4, 0, v243
    v_mul_u32_u24 v5, 205, v4
    v_lshrrev_b32 v5, 11, v5
    v_mul_u32_u24 v6, 10, v5
    v_sub_u32 v4, v4, v6
    v_lshl_add_u32 v4, v4, 4, s55
    v_lshrrev_b32 v100, 3, v5
    v_bfe_u32 v105, v5, 2, 1
    v_and_b32 v5, 3, v5
    v_mad_u32_u24 v110, v5, s53, v4
    v_add_u32 v4, 64, v243
    v_mul_u32_u24 v5, 205, v4
    v_lshrrev_b32 v5, 11, v5
    v_mul_u32_u24 v6, 10, v5
    v_sub_u32 v4, v4, v6
    v_lshl_add_u32 v4, v4, 4, s55
    v_lshrrev_b32 v101, 3, v5
    v_bfe_u32 v106, v5, 2, 1
    v_and_b32 v5, 3, v5
    v_mad_u32_u24 v111, v5, s53, v4
    v_add_u32 v4, 128, v243
    v_mul_u32_u24 v5, 205, v4
    v_lshrrev_b32 v5, 11, v5
    v_mul_u32_u24 v6, 10, v5
    v_sub_u32 v4, v4, v6
    v_lshl_add_u32 v4, v4, 4, s55
    v_lshrrev_b32 v102, 3, v5
    v_bfe_u32 v107, v5, 2, 1
    v_and_b32 v5, 3, v5
    v_mad_u32_u24 v112, v5, s53, v4
    v_add_u32 v4, 192, v243
    v_mul_u32_u24 v5, 205, v4
    v_lshrrev_b32 v5, 11, v5
    v_mul_u32_u24 v6, 10, v5
    v_sub_u32 v4, v4, v6
    v_lshl_add_u32 v4, v4, 4, s55
    v_lshrrev_b32 v103, 3, v5
    v_bfe_u32 v108, v5, 2, 1
    v_and_b32 v5, 3, v5
    v_mad_u32_u24 v113, v5, s53, v4
    v_add_u32 v4, 256, v243
    v_mul_u32_u24 v5, 205, v4
    v_lshrrev_b32 v5, 11, v5
    v_mul_u32_u24 v6, 10, v5
    v_sub_u32 v4, v4, v6
    v_lshl_add_u32 v4, v4, 4, s55
    v_lshrrev_b32 v104, 3, v5
    v_bfe_u32 v109, v5, 2, 1
    v_and_b32 v5, 3, v5
    v_mad_u32_u24 v114, v5, s53, v4
    s_lshl_b32 s44, s48, 1
    s_sub_u32 s44, 20, s44
    s_lshl_b32 s42, s44, 1
    s_add_u32 s42, s42, s46
    s_cmp_lt_u32 s42, 68
    s_cselect_b32 s45, 1, 0
    s_cmp_eq_u32 s43, 0
    s_cselect_b32 s42, s46, s42
    s_cselect_b32 s45, 3, s45
    s_mul_i32 s56, s44, 0
    s_add_u32 s56, s56, s42
    s_mul_i32 s57, s56, 241
    s_lshr_b32 s57, s57, 12
    s_mul_i32 s58, s57, 17
    s_sub_u32 s58, s56, s58
    s_cmp_ge_u32 s58, 12
    s_cbranch_scc1 sv_o0
    s_mov_b32 s28, s16
    s_mov_b32 s29, s17
    s_mov_b32 s30, 1966080
    s_mov_b32 s31, 0x20000
    s_lshr_b32 s59, s58, 1
    s_mul_i32 s59, s59, 3
    s_and_b32 s63, s58, 1
    s_lshl_b32 s63, s63, 1
    s_add_u32 s59, s59, s63
    s_mul_i32 s63, s58, 3
    s_sub_u32 s63, s63, 23
    s_cmp_ge_u32 s58, 8
    s_cselect_b32 s58, s63, s59
    s_mul_i32 s59, s57, 12
    s_add_u32 s59, s59, s58
    s_lshl_b32 s59, s59, 5
    s_movk_i32 s60, 10240
    s_movk_i32 s61, 5120
    s_mov_b32 s62, 1
    s_mov_b32 s67, 0
    s_branch sv_c0
sv_o0:
    s_mov_b32 s28, s8
    s_mov_b32 s29, s9
    s_mov_b32 s30, 819200
    s_mov_b32 s31, 0x20000
    s_sub_u32 s58, s58, 12
    s_mul_i32 s59, s57, 160
    s_mul_i32 s63, s58, 40
    s_movk_i32 s60, 10240
    s_cmp_eq_u32 s58, 4
    s_cselect_b32 s63, 16, s63
    s_cselect_b32 s60, 51200, s60
    s_cselect_b32 s61, 25600, s54
    s_cselect_b32 s67, 0, s54
    s_add_u32 s59, s59, s63
    s_mov_b32 s62, 0
sv_c0:
    s_mul_i32 s64, s59, 1280
    v_and_b32 v4, s62, v100
    v_xor_b32 v4, v4, v105
    v_mad_u32_u24 v4, v4, s61, v110
    v_mad_u32_u24 v4, v100, s60, v4
    v_lshrrev_b32 v5, 1, v100
    v_mad_u32_u24 v120, v5, s67, v4
    v_and_b32 v4, s62, v101
    v_xor_b32 v4, v4, v106
    v_mad_u32_u24 v4, v4, s61, v111
    v_mad_u32_u24 v4, v101, s60, v4
    v_lshrrev_b32 v5, 1, v101
    v_mad_u32_u24 v121, v5, s67, v4
    v_and_b32 v4, s62, v102
    v_xor_b32 v4, v4, v107
    v_mad_u32_u24 v4, v4, s61, v112
    v_mad_u32_u24 v4, v102, s60, v4
    v_lshrrev_b32 v5, 1, v102
    v_mad_u32_u24 v122, v5, s67, v4
    v_and_b32 v4, s62, v103
    v_xor_b32 v4, v4, v108
    v_mad_u32_u24 v4, v4, s61, v113
    v_mad_u32_u24 v4, v103, s60, v4
    v_lshrrev_b32 v5, 1, v103
    v_mad_u32_u24 v123, v5, s67, v4
    v_and_b32 v4, s62, v104
    v_xor_b32 v4, v4, v109
    v_mad_u32_u24 v4, v4, s61, v114
    v_mad_u32_u24 v4, v104, s60, v4
    v_lshrrev_b32 v5, 1, v104
    v_mad_u32_u24 v124, v5, s67, v4
    s_mul_i32 s56, s44, 1
    s_add_u32 s56, s56, s42
    s_mul_i32 s57, s56, 241
    s_lshr_b32 s57, s57, 12
    s_mul_i32 s58, s57, 17
    s_sub_u32 s58, s56, s58
    s_cmp_ge_u32 s58, 12
    s_cbranch_scc1 sv_o1
    s_mov_b32 s32, s16
    s_mov_b32 s33, s17
    s_mov_b32 s34, 1966080
    s_mov_b32 s35, 0x20000
    s_lshr_b32 s59, s58, 1
    s_mul_i32 s59, s59, 3
    s_and_b32 s63, s58, 1
    s_lshl_b32 s63, s63, 1
    s_add_u32 s59, s59, s63
    s_mul_i32 s63, s58, 3
    s_sub_u32 s63, s63, 23
    s_cmp_ge_u32 s58, 8
    s_cselect_b32 s58, s63, s59
    s_mul_i32 s59, s57, 12
    s_add_u32 s59, s59, s58
    s_lshl_b32 s59, s59, 5
    s_movk_i32 s60, 10240
    s_movk_i32 s61, 5120
    s_mov_b32 s62, 1
    s_mov_b32 s67, 0
    s_branch sv_c1
sv_o1:
    s_mov_b32 s32, s8
    s_mov_b32 s33, s9
    s_mov_b32 s34, 819200
    s_mov_b32 s35, 0x20000
    s_sub_u32 s58, s58, 12
    s_mul_i32 s59, s57, 160
    s_mul_i32 s63, s58, 40
    s_movk_i32 s60, 10240
    s_cmp_eq_u32 s58, 4
    s_cselect_b32 s63, 16, s63
    s_cselect_b32 s60, 51200, s60
    s_cselect_b32 s61, 25600, s54
    s_cselect_b32 s67, 0, s54
    s_add_u32 s59, s59, s63
    s_mov_b32 s62, 0
sv_c1:
    s_mul_i32 s65, s59, 1280
    v_and_b32 v4, s62, v100
    v_xor_b32 v4, v4, v105
    v_mad_u32_u24 v4, v4, s61, v110
    v_mad_u32_u24 v4, v100, s60, v4
    v_lshrrev_b32 v5, 1, v100
    v_mad_u32_u24 v125, v5, s67, v4
    v_and_b32 v4, s62, v101
    v_xor_b32 v4, v4, v106
    v_mad_u32_u24 v4, v4, s61, v111
    v_mad_u32_u24 v4, v101, s60, v4
    v_lshrrev_b32 v5, 1, v101
    v_mad_u32_u24 v126, v5, s67, v4
    v_and_b32 v4, s62, v102
    v_xor_b32 v4, v4, v107
    v_mad_u32_u24 v4, v4, s61, v112
    v_mad_u32_u24 v4, v102, s60, v4
    v_lshrrev_b32 v5, 1, v102
    v_mad_u32_u24 v127, v5, s67, v4
    v_and_b32 v4, s62, v103
    v_xor_b32 v4, v4, v108
    v_mad_u32_u24 v4, v4, s61, v113
    v_mad_u32_u24 v4, v103, s60, v4
    v_lshrrev_b32 v5, 1, v103
    v_mad_u32_u24 v128, v5, s67, v4
    v_and_b32 v4, s62, v104
    v_xor_b32 v4, v4, v109
    v_mad_u32_u24 v4, v4, s61, v114
    v_mad_u32_u24 v4, v104, s60, v4
    v_lshrrev_b32 v5, 1, v104
    v_mad_u32_u24 v129, v5, s67, v4
    s_mul_i32 s56, s44, 2
    s_add_u32 s56, s56, s42
    s_mul_i32 s57, s56, 241
    s_lshr_b32 s57, s57, 12
    s_mul_i32 s58, s57, 17
    s_sub_u32 s58, s56, s58
    s_cmp_ge_u32 s58, 12
    s_cbranch_scc1 sv_o2
    s_mov_b32 s36, s16
    s_mov_b32 s37, s17
    s_mov_b32 s38, 1966080
    s_mov_b32 s39, 0x20000
    s_lshr_b32 s59, s58, 1
    s_mul_i32 s59, s59, 3
    s_and_b32 s63, s58, 1
    s_lshl_b32 s63, s63, 1
    s_add_u32 s59, s59, s63
    s_mul_i32 s63, s58, 3
    s_sub_u32 s63, s63, 23
    s_cmp_ge_u32 s58, 8
    s_cselect_b32 s58, s63, s59
    s_mul_i32 s59, s57, 12
    s_add_u32 s59, s59, s58
    s_lshl_b32 s59, s59, 5
    s_movk_i32 s60, 10240
    s_movk_i32 s61, 5120
    s_mov_b32 s62, 1
    s_mov_b32 s67, 0
    s_branch sv_c2
sv_o2:
    s_mov_b32 s36, s8
    s_mov_b32 s37, s9
    s_mov_b32 s38, 819200
    s_mov_b32 s39, 0x20000
    s_sub_u32 s58, s58, 12
    s_mul_i32 s59, s57, 160
    s_mul_i32 s63, s58, 40
    s_movk_i32 s60, 10240
    s_cmp_eq_u32 s58, 4
    s_cselect_b32 s63, 16, s63
    s_cselect_b32 s60, 51200, s60
    s_cselect_b32 s61, 25600, s54
    s_cselect_b32 s67, 0, s54
    s_add_u32 s59, s59, s63
    s_mov_b32 s62, 0
sv_c2:
    s_mul_i32 s66, s59, 1280
    v_and_b32 v4, s62, v100
    v_xor_b32 v4, v4, v105
    v_mad_u32_u24 v4, v4, s61, v110
    v_mad_u32_u24 v4, v100, s60, v4
    v_lshrrev_b32 v5, 1, v100
    v_mad_u32_u24 v130, v5, s67, v4
    v_and_b32 v4, s62, v101
    v_xor_b32 v4, v4, v106
    v_mad_u32_u24 v4, v4, s61, v111
    v_mad_u32_u24 v4, v101, s60, v4
    v_lshrrev_b32 v5, 1, v101
    v_mad_u32_u24 v131, v5, s67, v4
    v_and_b32 v4, s62, v102
    v_xor_b32 v4, v4, v107
    v_mad_u32_u24 v4, v4, s61, v112
    v_mad_u32_u24 v4, v102, s60, v4
    v_lshrrev_b32 v5, 1, v102
    v_mad_u32_u24 v132, v5, s67, v4
    v_and_b32 v4, s62, v103
    v_xor_b32 v4, v4, v108
    v_mad_u32_u24 v4, v4, s61, v113
    v_mad_u32_u24 v4, v103, s60, v4
    v_lshrrev_b32 v5, 1, v103
    v_mad_u32_u24 v133, v5, s67, v4
    v_and_b32 v4, s62, v104
    v_xor_b32 v4, v4, v109
    v_mad_u32_u24 v4, v4, s61, v114
    v_mad_u32_u24 v4, v104, s60, v4
    v_lshrrev_b32 v5, 1, v104
    v_mad_u32_u24 v134, v5, s67, v4
    v_lshrrev_b32 v4, 4, v243
    v_bfe_u32 v5, v243, 2, 2
    v_lshl_add_u32 v4, v4, 3, v5
    v_mul_u32_u24 v4, 160, v4
    v_add_u32 v4, 141312, v4
    v_and_b32 v5, 3, v243
    v_lshl_add_u32 v26, v5, 4, v4
    v_lshl_add_u32 v27, v5, 3, v4
    v_lshlrev_b32 v28, 4, v243
    v_add_u32 v29, 4096, v28
    v_add_u32 v5, s41, v243
    v_lshlrev_b32 v20, 4, v5
    v_add_u32 v21, 1024, v20
    s_mov_b32 s56, 278528
    s_movk_i32 s57, 2048
    v_mov_b32 v9, 2130706432
    v_lshlrev_b32 v8, 2, v243
    v_add_u32 v8, 159744, v8
    v_lshrrev_b32 v6, 6, v5
    v_mul_lo_u32 v6, v6, s56
    v_bfe_u32 v7, v5, 2, 4
    v_lshl_add_u32 v6, v7, 8, v6
    v_and_b32 v7, 3, v5
    v_lshl_add_u32 v6, v7, 4, v6
    ds_write_b32 v8, v6 offset:0
    v_add_u32 v5, 64, v5
    v_lshrrev_b32 v6, 6, v5
    v_mul_lo_u32 v6, v6, s56
    v_bfe_u32 v7, v5, 2, 4
    v_lshl_add_u32 v6, v7, 8, v6
    v_and_b32 v7, 3, v5
    v_lshl_add_u32 v6, v7, 4, v6
    v_cmp_gt_u32 vcc, 44, v243
    v_cmp_gt_u32 s[58:59], s57, v5
    s_nop 0
    s_and_b64 vcc, vcc, s[58:59]
    v_cndmask_b32 v6, v9, v6, vcc
    ds_write_b32 v8, v6 offset:256
    s_max_i32 s56, s41, 0
    s_lshr_b32 s56, s56, 7
    s_add_u32 s57, s41, 175
    s_lshr_b32 s57, s57, 7
    s_min_u32 s57, s57, 15
    v_add_u32 v18, s56, v243
    v_min_u32 v18, s57, v18
    s_and_b32 s56, s46, 7
    s_add_u32 s56, s56, 16
    v_mov_b32 v4, s56
    v_cmp_gt_u32 vcc, 3, v243
    s_nop 1
    v_cndmask_b32 v18, v4, v18, vcc
    v_mul_u32_u24 v18, 256, v18
    v_mov_b32 v4, 68
    v_cndmask_b32 v19, v4, 16, vcc
    s_add_u32 s56, s50, 16
    s_mul_i32 s56, s56, 256
    v_mov_b32 v22, s56
    v_mov_b32 v23, s45
    s_lshr_b32 s56, s51, 4
    s_mul_i32 s56, s56, 256
    v_writelane_b32 v22, s56, 0
    v_writelane_b32 v23, 1, 0
    v_lshlrev_b32 v24, 4, v1
    v_cmp_eq_u32 vcc, 0, v2
    s_nop 1
    v_cndmask_b32 v24, v9, v24, vcc
    v_add_u32 v25, 156672, v28
    v_lshlrev_b32 v17, 7, v243
    v_lshlrev_b32 v16, 2, v243
    v_add_u32 v16, 160320, v16
    s_add_u32 s76, s22, 20971520
    s_addc_u32 s77, s23, 0
    s_mov_b32 s78, 32768
    s_mov_b32 s79, 0x20000
    v_mov_b32 v8, 0
    v_mov_b32 v9, 0
    v_mov_b32 v10, 0
    v_mov_b32 v11, 0
    s_add_u32 s24, s22, 9437184
    s_addc_u32 s25, s23, 0
    s_mov_b32 s26, 2785280
    s_mov_b32 s27, 0x20000
    v_mov_b32 v4, 0x3f803f80
    s_mul_i32 s56, s50, 348160
    s_mul_i32 s57, s42, 5120
    s_add_u32 s56, s56, s57
    s_mul_i32 s47, s44, 5120
    s_barrier
    s_barrier
    s_cmp_lg_u32 s2, 0
    s_cbranch_scc1 sv_n2
    s_waitcnt vmcnt(0)
    v_mov_b32 v5, 1
    s_mov_b64 exec, 1
    global_store_dword v30, v5, s[20:21] sc1
    s_mov_b64 exec, -1
sv_n2:
    s_waitcnt vmcnt(0)
    s_cmp_le_u32 s45, 0
    s_cbranch_scc1 sv_d3
    s_mov_b32 m0, 141312
    s_nop 0
    buffer_load_dwordx4 v120, s[28:31], s64 offen  lds
    s_mov_b32 m0, 142336
    s_nop 0
    buffer_load_dwordx4 v121, s[28:31], s64 offen  lds
    s_mov_b32 m0, 143360
    s_nop 0
    buffer_load_dwordx4 v122, s[28:31], s64 offen  lds
    s_mov_b32 m0, 144384
    s_nop 0
    buffer_load_dwordx4 v123, s[28:31], s64 offen  lds
    s_mov_b32 m0, 145408
    s_nop 0
    buffer_load_dwordx4 v124, s[28:31], s64 offen  lds
    s_cmp_le_u32 s45, 1
    s_cbranch_scc1 sv_d3
    s_mov_b32 m0, 146432
    s_nop 0
    buffer_load_dwordx4 v125, s[32:35], s65 offen  lds
    s_mov_b32 m0, 147456
    s_nop 0
    buffer_load_dwordx4 v126, s[32:35], s65 offen  lds
    s_mov_b32 m0, 148480
    s_nop 0
    buffer_load_dwordx4 v127, s[32:35], s65 offen  lds
    s_mov_b32 m0, 149504
    s_nop 0
    buffer_load_dwordx4 v128, s[32:35], s65 offen  lds
    s_mov_b32 m0, 150528
    s_nop 0
    buffer_load_dwordx4 v129, s[32:35], s65 offen  lds
    s_cmp_le_u32 s45, 2
    s_cbranch_scc1 sv_d3
    s_mov_b32 m0, 151552
    s_nop 0
    buffer_load_dwordx4 v130, s[36:39], s66 offen  lds
    s_mov_b32 m0, 152576
    s_nop 0
    buffer_load_dwordx4 v131, s[36:39], s66 offen  lds
    s_mov_b32 m0, 153600
    s_nop 0
    buffer_load_dwordx4 v132, s[36:39], s66 offen  lds
    s_mov_b32 m0, 154624
    s_nop 0
    buffer_load_dwordx4 v133, s[36:39], s66 offen  lds
    s_mov_b32 m0, 155648
    s_nop 0
    buffer_load_dwordx4 v134, s[36:39], s66 offen  lds
sv_d3:
    v_dot2c_f32_bf16 v8, v140, v4
    v_dot2c_f32_bf16 v10, v140, v140
    v_dot2c_f32_bf16 v8, v141, v4
    v_dot2c_f32_bf16 v10, v141, v141
    v_dot2c_f32_bf16 v8, v142, v4
    v_dot2c_f32_bf16 v10, v142, v142
    v_dot2c_f32_bf16 v8, v143, v4
    v_dot2c_f32_bf16 v10, v143, v143
    v_dot2c_f32_bf16 v8, v144, v4
    v_dot2c_f32_bf16 v10, v144, v144
    v_dot2c_f32_bf16 v8, v145, v4
    v_dot2c_f32_bf16 v10, v145, v145
    v_dot2c_f32_bf16 v8, v146, v4
    v_dot2c_f32_bf16 v10, v146, v146
    v_dot2c_f32_bf16 v8, v147, v4
    v_dot2c_f32_bf16 v10, v147, v147
    v_dot2c_f32_bf16 v8, v148, v4
    v_dot2c_f32_bf16 v10, v148, v148
    v_dot2c_f32_bf16 v8, v149, v4
    v_dot2c_f32_bf16 v10, v149, v149
    v_dot2c_f32_bf16 v8, v150, v4
    v_dot2c_f32_bf16 v10, v150, v150
    v_dot2c_f32_bf16 v8, v151, v4
    v_dot2c_f32_bf16 v10, v151, v151
    v_dot2c_f32_bf16 v8, v152, v4
    v_dot2c_f32_bf16 v10, v152, v152
    v_dot2c_f32_bf16 v8, v153, v4
    v_dot2c_f32_bf16 v10, v153, v153
    v_dot2c_f32_bf16 v8, v154, v4
    v_dot2c_f32_bf16 v10, v154, v154
    v_dot2c_f32_bf16 v8, v155, v4
    v_dot2c_f32_bf16 v10, v155, v155
    v_dot2c_f32_bf16 v8, v156, v4
    v_dot2c_f32_bf16 v10, v156, v156
    v_dot2c_f32_bf16 v8, v157, v4
    v_dot2c_f32_bf16 v10, v157, v157
    v_dot2c_f32_bf16 v8, v158, v4
    v_dot2c_f32_bf16 v10, v158, v158
    v_dot2c_f32_bf16 v8, v159, v4
    v_dot2c_f32_bf16 v10, v159, v159
    v_dot2c_f32_bf16 v9, v160, v4
    v_dot2c_f32_bf16 v11, v160, v160
    v_dot2c_f32_bf16 v9, v161, v4
    v_dot2c_f32_bf16 v11, v161, v161
    v_dot2c_f32_bf16 v9, v162, v4
    v_dot2c_f32_bf16 v11, v162, v162
    v_dot2c_f32_bf16 v9, v163, v4
    v_dot2c_f32_bf16 v11, v163, v163
    v_dot2c_f32_bf16 v9, v164, v4
    v_dot2c_f32_bf16 v11, v164, v164
    v_dot2c_f32_bf16 v9, v165, v4
    v_dot2c_f32_bf16 v11, v165, v165
    v_dot2c_f32_bf16 v9, v166, v4
    v_dot2c_f32_bf16 v11, v166, v166
    v_dot2c_f32_bf16 v9, v167, v4
    v_dot2c_f32_bf16 v11, v167, v167
    v_dot2c_f32_bf16 v9, v168, v4
    v_dot2c_f32_bf16 v11, v168, v168
    v_dot2c_f32_bf16 v9, v169, v4
    v_dot2c_f32_bf16 v11, v169, v169
    v_dot2c_f32_bf16 v9, v170, v4
    v_dot2c_f32_bf16 v11, v170, v170
    v_dot2c_f32_bf16 v9, v171, v4
    v_dot2c_f32_bf16 v11, v171, v171
    v_dot2c_f32_bf16 v9, v172, v4
    v_dot2c_f32_bf16 v11, v172, v172
    v_dot2c_f32_bf16 v9, v173, v4
    v_dot2c_f32_bf16 v11, v173, v173
    v_dot2c_f32_bf16 v9, v174, v4
    v_dot2c_f32_bf16 v11, v174, v174
    v_dot2c_f32_bf16 v9, v175, v4
    v_dot2c_f32_bf16 v11, v175, v175
    v_dot2c_f32_bf16 v9, v176, v4
    v_dot2c_f32_bf16 v11, v176, v176
    v_dot2c_f32_bf16 v9, v177, v4
    v_dot2c_f32_bf16 v11, v177, v177
    v_dot2c_f32_bf16 v9, v178, v4
    v_dot2c_f32_bf16 v11, v178, v178
    v_dot2c_f32_bf16 v9, v179, v4
    v_dot2c_f32_bf16 v11, v179, v179
    s_nop 3
    v_add_f32_dpp v8, v8, v8 row_ror:8 row_mask:0xf bank_mask:0xf
    v_add_f32_dpp v9, v9, v9 row_ror:8 row_mask:0xf bank_mask:0xf
    v_add_f32_dpp v10, v10, v10 row_ror:8 row_mask:0xf bank_mask:0xf
    v_add_f32_dpp v11, v11, v11 row_ror:8 row_mask:0xf bank_mask:0xf
    v_add_f32_dpp v8, v8, v8 row_ror:4 row_mask:0xf bank_mask:0xf
    v_add_f32_dpp v9, v9, v9 row_ror:4 row_mask:0xf bank_mask:0xf
    v_add_f32_dpp v10, v10, v10 row_ror:4 row_mask:0xf bank_mask:0xf
    v_add_f32_dpp v11, v11, v11 row_ror:4 row_mask:0xf bank_mask:0xf
    v_add_f32_dpp v8, v8, v8 row_ror:2 row_mask:0xf bank_mask:0xf
    v_add_f32_dpp v9, v9, v9 row_ror:2 row_mask:0xf bank_mask:0xf
    v_add_f32_dpp v10, v10, v10 row_ror:2 row_mask:0xf bank_mask:0xf
    v_add_f32_dpp v11, v11, v11 row_ror:2 row_mask:0xf bank_mask:0xf
    v_add_f32_dpp v8, v8, v8 row_ror:1 row_mask:0xf bank_mask:0xf
    v_add_f32_dpp v9, v9, v9 row_ror:1 row_mask:0xf bank_mask:0xf
    v_add_f32_dpp v10, v10, v10 row_ror:1 row_mask:0xf bank_mask:0xf
    v_add_f32_dpp v11, v11, v11 row_ror:1 row_mask:0xf bank_mask:0xf
    s_mov_b32 s57, 0x3acccccd
    v_mul_f32 v32, s57, v8
    v_mul_f32 v34, s57, v10
    v_fma_f32 v34, -v32, v32, v34
    v_max_f32 v34, 0, v34
    v_add_f32 v34, 0x3727c5ac, v34
    v_rsq_f32 v33, v34
    v_sub_f32 v32, 0, v32
    v_mov_b32 v35, 0
    buffer_store_dwordx4 v[32:35], v24, s[76:79], 0 offen offset:0 sc1
    v_mul_f32 v36, s57, v9
    v_mul_f32 v38, s57, v11
    v_fma_f32 v38, -v36, v36, v38
    v_max_f32 v38, 0, v38
    v_add_f32 v38, 0x3727c5ac, v38
    v_rsq_f32 v37, v38
    v_sub_f32 v36, 0, v36
    v_mov_b32 v39, 0
    buffer_store_dwordx4 v[36:39], v24, s[76:79], 0 offen offset:64 sc1
    s_mov_b32 s68, 1
    s_mov_b32 s69, 0
sv_lp:
    s_barrier
    s_add_u32 s68, s68, 1
    s_cmp_eq_u32 s68, 4
    s_cbranch_scc1 sv_e1
    s_cmp_eq_u32 s68, 5
    s_cbranch_scc1 sv_e2
    s_cmp_eq_u32 s68, 7
    s_cbranch_scc1 sv_e3
sv_er:
    s_add_u32 s69, s69, 1
    s_cmp_lt_u32 s69, 11
    s_cbranch_scc1 sv_lp
    s_branch sv_go
sv_e1:
    s_waitcnt vmcnt(0)
    s_cmp_le_u32 s45, 0
    s_cbranch_scc1 sv_s0
    ds_read_b64_tr_b16 v[40:41], v26 offset:0
    ds_read_b64_tr_b16 v[42:43], v26 offset:640
    ds_read_b64_tr_b16 v[44:45], v26 offset:8
    ds_read_b64_tr_b16 v[46:47], v26 offset:648
    ds_read_b64_tr_b16 v[48:49], v26 offset:64
    ds_read_b64_tr_b16 v[50:51], v26 offset:704
    ds_read_b64_tr_b16 v[52:53], v26 offset:72
    ds_read_b64_tr_b16 v[54:55], v26 offset:712
    ds_read_b64_tr_b16 v[56:57], v27 offset:128
    ds_read_b64_tr_b16 v[58:59], v27 offset:768
    s_waitcnt lgkmcnt(0)
    buffer_store_dwordx4 v[40:43], v28, s[24:27], s56 offen offset:0 sc1
    buffer_store_dwordx4 v[44:47], v28, s[24:27], s56 offen offset:1024 sc1
    buffer_store_dwordx4 v[48:51], v28, s[24:27], s56 offen offset:2048 sc1
    buffer_store_dwordx4 v[52:55], v28, s[24:27], s56 offen offset:3072 sc1
    buffer_store_dwordx4 v[56:59], v29, s[24:27], s56 offen sc1
    s_add_u32 s56, s56, s47
sv_s0:
    s_branch sv_er
sv_e2:
    s_cmp_le_u32 s45, 1
    s_cbranch_scc1 sv_s1
    ds_read_b64_tr_b16 v[60:61], v26 offset:5120
    ds_read_b64_tr_b16 v[62:63], v26 offset:5760
    ds_read_b64_tr_b16 v[64:65], v26 offset:5128
    ds_read_b64_tr_b16 v[66:67], v26 offset:5768
    ds_read_b64_tr_b16 v[68:69], v26 offset:5184
    ds_read_b64_tr_b16 v[70:71], v26 offset:5824
    ds_read_b64_tr_b16 v[72:73], v26 offset:5192
    ds_read_b64_tr_b16 v[74:75], v26 offset:5832
    ds_read_b64_tr_b16 v[76:77], v27 offset:5248
    ds_read_b64_tr_b16 v[78:79], v27 offset:5888
    s_waitcnt lgkmcnt(0)
    buffer_store_dwordx4 v[60:63], v28, s[24:27], s56 offen offset:0 sc1
    buffer_store_dwordx4 v[64:67], v28, s[24:27], s56 offen offset:1024 sc1
    buffer_store_dwordx4 v[68:71], v28, s[24:27], s56 offen offset:2048 sc1
    buffer_store_dwordx4 v[72:75], v28, s[24:27], s56 offen offset:3072 sc1
    buffer_store_dwordx4 v[76:79], v29, s[24:27], s56 offen sc1
    s_add_u32 s56, s56, s47
sv_s1:
    s_cmp_le_u32 s45, 2
    s_cbranch_scc1 sv_s2
    ds_read_b64_tr_b16 v[80:81], v26 offset:10240
    ds_read_b64_tr_b16 v[82:83], v26 offset:10880
    ds_read_b64_tr_b16 v[84:85], v26 offset:10248
    ds_read_b64_tr_b16 v[86:87], v26 offset:10888
    ds_read_b64_tr_b16 v[88:89], v26 offset:10304
    ds_read_b64_tr_b16 v[90:91], v26 offset:10944
    ds_read_b64_tr_b16 v[92:93], v26 offset:10312
    ds_read_b64_tr_b16 v[94:95], v26 offset:10952
    ds_read_b64_tr_b16 v[96:97], v27 offset:10368
    ds_read_b64_tr_b16 v[98:99], v27 offset:11008
    s_waitcnt lgkmcnt(0)
    buffer_store_dwordx4 v[80:83], v28, s[24:27], s56 offen offset:0 sc1
    buffer_store_dwordx4 v[84:87], v28, s[24:27], s56 offen offset:1024 sc1
    buffer_store_dwordx4 v[88:91], v28, s[24:27], s56 offen offset:2048 sc1
    buffer_store_dwordx4 v[92:95], v28, s[24:27], s56 offen offset:3072 sc1
    buffer_store_dwordx4 v[96:99], v29, s[24:27], s56 offen sc1
    s_add_u32 s56, s56, s47
sv_s2:
    global_load_dword v31, v30, s[20:21] sc1
    s_branch sv_er
sv_e3:
    s_mov_b32 s70, 0
    s_branch pl1_chk
pl1_top:
    global_load_dword v31, v30, s[20:21] sc1
pl1_chk:
    s_waitcnt vmcnt(0)
    v_cmp_ne_u32 vcc, 1, v31
    s_nop 1
    s_cbranch_vccz pl1_ok
    s_sleep 2
    s_add_u32 s70, s70, 1
    s_cmp_lt_u32 s70, 30000
    s_cbranch_scc1 pl1_top
    s_endpgm
pl1_ok:
    s_mov_b64 exec, 3
    global_atomic_add v22, v23, s[10:11]
    s_mov_b64 exec, -1
    s_branch sv_er
sv_go:
    global_load_dword v31, v18, s[10:11] sc1
    s_barrier
    s_barrier
    s_mov_b32 s70, 0
    s_branch pl2_chk
pl2_top:
    global_load_dword v31, v18, s[10:11] sc1
pl2_chk:
    s_waitcnt vmcnt(0)
    v_cmp_ne_u32 vcc, v19, v31
    s_nop 1
    s_cbranch_vccz pl2_ok
    s_sleep 2
    s_add_u32 s70, s70, 1
    s_cmp_lt_u32 s70, 30000
    s_cbranch_scc1 pl2_top
    s_endpgm
pl2_ok:
    buffer_load_dwordx4 v[32:35], v20, s[76:79], 0 offen sc1
    buffer_load_dwordx4 v[36:39], v21, s[76:79], 0 offen offset:0 sc1
    buffer_load_dwordx4 v[40:43], v21, s[76:79], 0 offen offset:1024 sc1
    s_barrier
    s_barrier
    s_mov_b32 s56, 0xbdd2d3e8
    s_cmp_eq_u32 s43, 1
    s_cselect_b32 s57, 1.0, 0xc0135761
    s_waitcnt vmcnt(0)
    s_getpc_b64 s[58:59]
sv_pc:
    s_sub_u32 s58, s58, sv_pc-k_gemm2
    s_subb_u32 s59, s59, 0
    v_min_u32 v48, k_end-k_gemm2-4, v17
    v_and_b32 v48, -4, v48
    global_load_dword v48, v48, s[58:59]
    v_add_u32 v17, 8192, v17
    v_min_u32 v49, k_end-k_gemm2-4, v17
    v_and_b32 v49, -4, v49
    global_load_dword v49, v49, s[58:59]
    v_add_u32 v17, 8192, v17
    v_min_u32 v50, k_end-k_gemm2-4, v17
    v_and_b32 v50, -4, v50
    global_load_dword v50, v50, s[58:59]
    v_add_u32 v17, 8192, v17
    v_min_u32 v51, k_end-k_gemm2-4, v17
    v_and_b32 v51, -4, v51
    global_load_dword v51, v51, s[58:59]
    v_mov_b32 v35, v34
    v_mul_f32 v34, v33, v33
    v_mul_f32 v34, v34, v33
    v_mul_f32 v34, s56, v34
    v_mul_f32 v33, s57, v33
    ds_write_b128 v25, v[32:35] offset:0
    ds_write2st64_b32 v16, v32, v33 offset0:0 offset1:3
    v_mov_b32 v39, v38
    v_mul_f32 v38, v37, v37
    v_mul_f32 v38, v38, v37
    v_mul_f32 v38, s56, v38
    v_mul_f32 v37, s57, v37
    ds_write_b128 v25, v[36:39] offset:1024
    ds_write2st64_b32 v16, v36, v37 offset0:1 offset1:4
    v_mov_b32 v43, v42
    v_mul_f32 v42, v41, v41
    v_mul_f32 v42, v42, v41
    v_mul_f32 v42, s56, v42
    v_mul_f32 v41, s57, v41
    ds_write_b128 v25, v[40:43] offset:2048
    ds_write2st64_b32 v16, v40, v41 offset0:2 offset1:5
    s_waitcnt lgkmcnt(0)
    s_add_u32 s36, s22, 9437184
    s_addc_u32 s37, s23, 0
    s_mov_b32 s38, 2785280
    s_mov_b32 s39, 0x20000
    v_lshlrev_b32 v248, 4, v243
    s_lshr_b32 s47, s2, 6
    s_bfe_u32 s48, s2, 0x30003
    s_mul_i32 s49, s48, 348160
    s_mul_i32 s50, s40, 87040
    s_add_u32 s49, s49, s50
    s_lshl_b32 s47, s47, 1
    s_add_u32 s48, s48, s47
    s_add_u32 s74, s48, 0
    s_and_b32 s74, s74, 7
    s_mul_i32 s74, s74, 5120
    s_add_u32 s74, s74, s49
    s_add_u32 s75, s74, 4096
    s_add_u32 s76, s48, 1
    s_and_b32 s76, s76, 7
    s_mul_i32 s76, s76, 5120
    s_add_u32 s76, s76, s49
    s_add_u32 s77, s76, 4096
    s_barrier
    buffer_load_dwordx4 v[80:83], v248, s[36:39], s74 offen offset:0 sc1
    buffer_load_dwordx4 v[84:87], v248, s[36:39], s74 offen offset:1024 sc1
    buffer_load_dwordx4 v[88:91], v248, s[36:39], s74 offen offset:2048 sc1
    buffer_load_dwordx4 v[92:95], v248, s[36:39], s74 offen offset:3072 sc1
    buffer_load_dwordx4 v[96:99], v248, s[36:39], s75 offen sc1
    buffer_load_dwordx4 v[100:103], v248, s[36:39], s76 offen offset:0 sc1
    buffer_load_dwordx4 v[104:107], v248, s[36:39], s76 offen offset:1024 sc1
    buffer_load_dwordx4 v[108:111], v248, s[36:39], s76 offen offset:2048 sc1
    buffer_load_dwordx4 v[112:115], v248, s[36:39], s76 offen offset:3072 sc1
    buffer_load_dwordx4 v[116:119], v248, s[36:39], s77 offen sc1
    s_barrier
    s_branch k_gemm2
k_cons:
    s_cmp_eq_u32 s43, 1
    s_cbranch_scc1 k_consq
    v_mov_b32 v168, 0
    v_mov_b32 v169, 0
    v_mov_b32 v170, 0
    v_mov_b32 v171, 0
    v_lshrrev_b32 v176, 4, v243
    v_and_b32 v177, 15, v243
    v_bfe_u32 v178, v243, 2, 2
    v_and_b32 v179, 3, v243
    v_mfma_f32_32x32x16_bf16 v[0:15], v[168:171], v[168:171], 0
    v_mfma_f32_32x32x16_bf16 v[16:31], v[168:171], v[168:171], 0
    v_mfma_f32_32x32x16_bf16 v[32:47], v[168:171], v[168:171], 0
    v_mfma_f32_32x32x16_bf16 v[48:63], v[168:171], v[168:171], 0
    v_mfma_f32_32x32x16_bf16 v[64:79], v[168:171], v[168:171], 0
    v_mfma_f32_32x32x16_bf16 v[80:95], v[168:171], v[168:171], 0
    v_mfma_f32_32x32x16_bf16 v[96:111], v[168:171], v[168:171], 0
    v_mfma_f32_32x32x16_bf16 v[112:127], v[168:171], v[168:171], 0
    v_mfma_f32_32x32x16_bf16 v[128:143], v[168:171], v[168:171], 0
    v_mfma_f32_32x32x16_bf16 v[144:159], v[168:171], v[168:171], 0
    v_mfma_f32_16x16x32_bf16 v[160:163], v[168:171], v[168:171], 0
    v_mfma_f32_16x16x32_bf16 v[164:167], v[168:171], v[168:171], 0
    v_lshrrev_b32 v180, 1, v177
    v_xor_b32 v180, v180, v176
    v_lshlrev_b32 v180, 4, v180
    v_lshl_or_b32 v180, v177, 7, v180
    v_add_u32 v240, 98304, v180
    v_xor_b32 v241, 64, v240
    v_mov_b32 v238, v240
    v_mov_b32 v239, v241
    v_mov_b32 v242, 0x3f803f80
    v_cmp_eq_u32 s[64:65], 15, v177
    v_mov_b32 v180, 160256
    ds_write_b128 v180, v[168:171]
    v_lshlrev_b32 v248, 4, v177
    v_add_u32 v248, 156672, v248
    v_lshrrev_b32 v180, 1, v178
    v_lshlrev_b32 v180, 2, v180
    v_and_b32 v181, 1, v176
    v_or_b32 v180, v180, v181
    v_lshlrev_b32 v180, 4, v180
    v_lshl_or_b32 v180, v178, 7, v180
    v_lshl_or_b32 v180, v176, 10, v180
    s_lshr_b32 s51, s40, 1
    s_mul_i32 s51, s51, 3
    s_add_u32 s52, s51, 1
    s_and_b32 s53, s40, 1
    s_lshl_b32 s54, s53, 1
    s_add_u32 s51, s51, s54
    v_and_b32 v181, 1, v179
    v_lshlrev_b32 v182, 4, v179
    v_lshl_or_b32 v182, v181, 3, v182
    v_xor_b32 v182, v182, v180
    s_and_b32 s54, s51, 1
    s_lshl_b32 s54, s54, 6
    s_lshr_b32 s55, s51, 1
    s_lshl_b32 s55, s55, 12
    v_xor_b32 v182, s54, v182
    v_add_u32 v232, s55, v182
    v_xor_b32 v233, 8, v232
    v_lshrrev_b32 v182, 1, v179
    v_xor_b32 v181, v181, v182
    v_lshlrev_b32 v182, 4, v182
    v_lshl_or_b32 v182, v181, 3, v182
    v_xor_b32 v182, v182, v180
    s_and_b32 s54, s52, 1
    s_lshl_b32 s54, s54, 6
    s_lshl_b32 s56, s53, 5
    s_or_b32 s54, s54, s56
    s_lshr_b32 s55, s52, 1
    s_lshl_b32 s55, s55, 12
    v_xor_b32 v182, s54, v182
    v_add_u32 v234, s55, v182
    v_add_u32 v235, 49152, v232
    v_add_u32 v236, 49152, v233
    v_add_u32 v237, 49152, v234
    v_lshrrev_b32 v183, 1, v176
    s_lshl_b32 s56, s53, 1
    v_add_u32 v183, s56, v183
    s_lshr_b32 s54, s44, 1
    s_mul_i32 s54, s54, 17
    s_and_b32 s57, s44, 1
    s_lshl_b32 s57, s57, 2
    s_add_u32 s57, s57, s40
    s_add_u32 s55, s54, s57
    s_lshl_b32 s55, s55, 12
    v_lshl_add_u32 v251, v176, 6, s55
    s_lshr_b32 s57, s57, 1
    s_add_u32 s55, s54, s57
    s_add_u32 s55, s55, 8
    s_lshl_b32 s55, s55, 12
    v_lshl_add_u32 v252, v183, 6, s55
    s_mov_b32 s62, s41
    s_add_u32 s63, s41, 107
    s_movk_i32 s66, 607
    s_mov_b32 s67, 0
    s_waitcnt lgkmcnt(0)
    s_lshr_b32 s62, s62, 6
    s_min_u32 s63, s63, 2047
    s_lshr_b32 s63, s63, 6
    s_lshr_b32 s20, s44, 1
    s_add_u32 s20, s20, 32
    s_and_b32 s21, s44, 1
    s_lshl_b32 s21, s21, 2
    s_add_u32 s12, s62, 0
    s_lshl_b32 s13, s12, 6
    s_mul_i32 s13, s13, s66
    s_lshr_b32 s13, s13, 16
    s_sub_u32 s13, s45, s13
    s_lshl_b32 s13, s13, 3
    s_add_u32 s13, s13, s21
    s_lshl_b32 s13, 1, s13
    s_lshl_b32 s12, s12, 2
    s_add_u32 s12, s12, s20
    s_mul_i32 s12, s12, 256
    s_add_u32 s12, s12, s67
    s_add_u32 s14, s62, 1
    s_lshl_b32 s15, s14, 6
    s_mul_i32 s15, s15, s66
    s_lshr_b32 s15, s15, 16
    s_sub_u32 s15, s45, s15
    s_lshl_b32 s15, s15, 3
    s_add_u32 s15, s15, s21
    s_lshl_b32 s15, 1, s15
    s_lshl_b32 s14, s14, 2
    s_add_u32 s14, s14, s20
    s_mul_i32 s14, s14, 256
    s_add_u32 s14, s14, s67
    s_add_u32 s16, s62, 2
    s_lshl_b32 s17, s16, 6
    s_mul_i32 s17, s17, s66
    s_lshr_b32 s17, s17, 16
    s_sub_u32 s17, s45, s17
    s_lshl_b32 s17, s17, 3
    s_add_u32 s17, s17, s21
    s_lshl_b32 s17, 1, s17
    s_lshl_b32 s16, s16, 2
    s_add_u32 s16, s16, s20
    s_mul_i32 s16, s16, 256
    s_add_u32 s16, s16, s67
    s_add_u32 s18, s62, 3
    s_lshl_b32 s19, s18, 6
    s_mul_i32 s19, s19, s66
    s_lshr_b32 s19, s19, 16
    s_sub_u32 s19, s45, s19
    s_lshl_b32 s19, s19, 3
    s_add_u32 s19, s19, s21
    s_lshl_b32 s19, 1, s19
    s_lshl_b32 s18, s18, 2
    s_add_u32 s18, s18, s20
    s_mul_i32 s18, s18, 256
    s_add_u32 s18, s18, s67
    s_sub_u32 s63, s63, s62
    v_lshlrev_b32 v249, 2, v177
    v_add_u32 v249, 159744, v249
    v_and_b32 v180, 1, v176
    v_lshl_add_u32 v250, v180, 6, v249
    s_waitcnt lgkmcnt(0)
    s_add_u32 s10, s22, 21037056
    s_addc_u32 s11, s23, 0
    s_mov_b32 s36, s22
    s_mov_b32 s37, s23
    s_mov_b32 s38, 8912896
    s_mov_b32 s39, 0x20000
    s_mov_b32 s60, 0
    s_mov_b32 s61, 0
    s_barrier
    ds_read_b64_tr_b16 v[168:169], v232 offset:0
    ds_read_b64_tr_b16 v[170:171], v232 offset:512
    ds_read_b64_tr_b16 v[172:173], v233 offset:0
    ds_read_b64_tr_b16 v[174:175], v233 offset:512
    ds_read_b64_tr_b16 v[176:177], v234 offset:0
    ds_read_b64_tr_b16 v[178:179], v234 offset:512
    ds_read_b64_tr_b16 v[180:181], v232 offset:12288
    ds_read_b64_tr_b16 v[182:183], v232 offset:12800
    ds_read_b64_tr_b16 v[184:185], v233 offset:12288
    ds_read_b64_tr_b16 v[186:187], v233 offset:12800
    ds_read_b64_tr_b16 v[188:189], v234 offset:12288
    ds_read_b64_tr_b16 v[190:191], v234 offset:12800
    ds_read_b128 v[216:219], v238 offset:0
    ds_read_b128 v[220:223], v238 offset:2048
    ds_read_b128 v[224:227], v238 offset:4096
cg_loop:
    s_waitcnt lgkmcnt(2)
    v_mfma_f32_16x16x32_bf16 v[0:3], v[168:171], v[216:219], v[0:3]
    ds_read_b128 v[228:231], v238 offset:6144
    v_mfma_f32_16x16x32_bf16 v[28:31], v[172:175], v[216:219], v[28:31]
    s_barrier
    v_mfma_f32_16x16x32_bf16 v[56:59], v[176:179], v[216:219], v[56:59]
    ds_read_b64_tr_b16 v[192:193], v232 offset:24576
    v_mfma_f32_16x16x32_bf16 v[84:87], v[180:183], v[216:219], v[84:87]
    ds_read_b64_tr_b16 v[194:195], v232 offset:25088
    v_mfma_f32_16x16x32_bf16 v[112:115], v[184:187], v[216:219], v[112:115]
    ds_read_b64_tr_b16 v[196:197], v233 offset:24576
    v_mfma_f32_16x16x32_bf16 v[140:143], v[188:191], v[216:219], v[140:143]
    s_waitcnt lgkmcnt(5)
    v_mfma_f32_16x16x32_bf16 v[4:7], v[168:171], v[220:223], v[4:7]
    ds_read_b128 v[216:219], v238 offset:8192
    v_mfma_f32_16x16x32_bf16 v[32:35], v[172:175], v[220:223], v[32:35]
    ds_read_b64_tr_b16 v[198:199], v233 offset:25088
    v_mfma_f32_16x16x32_bf16 v[60:63], v[176:179], v[220:223], v[60:63]
    ds_read_b64_tr_b16 v[200:201], v234 offset:24576
    v_mfma_f32_16x16x32_bf16 v[88:91], v[180:183], v[220:223], v[88:91]
    ds_read_b64_tr_b16 v[202:203], v234 offset:25088
    v_mfma_f32_16x16x32_bf16 v[116:119], v[184:187], v[220:223], v[116:119]
    v_mfma_f32_16x16x32_bf16 v[144:147], v[188:191], v[220:223], v[144:147]
    s_waitcnt lgkmcnt(8)
    v_mfma_f32_16x16x32_bf16 v[8:11], v[168:171], v[224:227], v[8:11]
    ds_read_b128 v[220:223], v238 offset:10240
    v_mfma_f32_16x16x32_bf16 v[36:39], v[172:175], v[224:227], v[36:39]
    ds_read_b64_tr_b16 v[204:205], v232 offset:36864
    v_mfma_f32_16x16x32_bf16 v[64:67], v[176:179], v[224:227], v[64:67]
    ds_read_b64_tr_b16 v[206:207], v232 offset:37376
    v_mfma_f32_16x16x32_bf16 v[92:95], v[180:183], v[224:227], v[92:95]
    ds_read_b64_tr_b16 v[208:209], v233 offset:36864
    v_mfma_f32_16x16x32_bf16 v[120:123], v[184:187], v[224:227], v[120:123]
    v_mfma_f32_16x16x32_bf16 v[148:151], v[188:191], v[224:227], v[148:151]
    s_waitcnt lgkmcnt(11)
    v_mfma_f32_16x16x32_bf16 v[12:15], v[168:171], v[228:231], v[12:15]
    ds_read_b128 v[224:227], v238 offset:12288
    v_mfma_f32_16x16x32_bf16 v[40:43], v[172:175], v[228:231], v[40:43]
    ds_read_b64_tr_b16 v[210:211], v233 offset:37376
    v_mfma_f32_16x16x32_bf16 v[68:71], v[176:179], v[228:231], v[68:71]
    ds_read_b64_tr_b16 v[212:213], v234 offset:36864
    v_mfma_f32_16x16x32_bf16 v[96:99], v[180:183], v[228:231], v[96:99]
    ds_read_b64_tr_b16 v[214:215], v234 offset:37376
    v_mfma_f32_16x16x32_bf16 v[124:127], v[184:187], v[228:231], v[124:127]
    v_mfma_f32_16x16x32_bf16 v[152:155], v[188:191], v[228:231], v[152:155]
    s_waitcnt lgkmcnt(11)
    v_mfma_f32_16x16x32_bf16 v[16:19], v[168:171], v[216:219], v[16:19]
    ds_read_b128 v[228:231], v239 offset:0
    v_mfma_f32_16x16x32_bf16 v[44:47], v[172:175], v[216:219], v[44:47]
    s_add_u32 s60, s60, 14336
    s_cmp_ge_u32 s60, 43008
    v_mfma_f32_16x16x32_bf16 v[72:75], v[176:179], v[216:219], v[72:75]
    s_cselect_b32 s60, 0, s60
    v_add_u32 v238, s60, v240
    v_mfma_f32_16x16x32_bf16 v[100:103], v[180:183], v[216:219], v[100:103]
    v_mfma_f32_16x16x32_bf16 v[128:131], v[184:187], v[216:219], v[128:131]
    v_mfma_f32_16x16x32_bf16 v[156:159], v[188:191], v[216:219], v[156:159]
    s_waitcnt lgkmcnt(8)
    v_mfma_f32_16x16x32_bf16 v[20:23], v[168:171], v[220:223], v[20:23]
    ds_read_b128 v[216:219], v239 offset:2048
    v_mfma_f32_16x16x32_bf16 v[48:51], v[172:175], v[220:223], v[48:51]
    s_waitcnt lgkmcnt(5)
    v_cndmask_b32 v224, v224, v242, s[64:65]
    v_cndmask_b32 v225, v225, v242, s[64:65]
    v_mfma_f32_16x16x32_bf16 v[76:79], v[176:179], v[220:223], v[76:79]
    v_cndmask_b32 v226, v226, v242, s[64:65]
    v_cndmask_b32 v227, v227, v242, s[64:65]
    v_mfma_f32_16x16x32_bf16 v[104:107], v[180:183], v[220:223], v[104:107]
    v_mfma_f32_16x16x32_bf16 v[132:135], v[184:187], v[220:223], v[132:135]
    v_mfma_f32_16x16x32_bf16 v[160:163], v[188:191], v[220:223], v[160:163]
    v_mfma_f32_16x16x32_bf16 v[24:27], v[168:171], v[224:227], v[24:27]
    ds_read_b128 v[220:223], v239 offset:4096
    v_mfma_f32_16x16x32_bf16 v[52:55], v[172:175], v[224:227], v[52:55]
    v_mfma_f32_16x16x32_bf16 v[80:83], v[176:179], v[224:227], v[80:83]
    v_mfma_f32_16x16x32_bf16 v[108:111], v[180:183], v[224:227], v[108:111]
    v_mfma_f32_16x16x32_bf16 v[136:139], v[184:187], v[224:227], v[136:139]
    v_mfma_f32_16x16x32_bf16 v[164:167], v[188:191], v[224:227], v[164:167]
    s_waitcnt lgkmcnt(2)
    v_mfma_f32_16x16x32_bf16 v[0:3], v[192:195], v[228:231], v[0:3]
    ds_read_b128 v[224:227], v239 offset:6144
    v_mfma_f32_16x16x32_bf16 v[28:31], v[196:199], v[228:231], v[28:31]
    s_barrier
    v_mfma_f32_16x16x32_bf16 v[56:59], v[200:203], v[228:231], v[56:59]
    ds_read_b64_tr_b16 v[168:169], v235 offset:0
    v_mfma_f32_16x16x32_bf16 v[84:87], v[204:207], v[228:231], v[84:87]
    ds_read_b64_tr_b16 v[170:171], v235 offset:512
    v_mfma_f32_16x16x32_bf16 v[112:115], v[208:211], v[228:231], v[112:115]
    ds_read_b64_tr_b16 v[172:173], v236 offset:0
    v_mfma_f32_16x16x32_bf16 v[140:143], v[212:215], v[228:231], v[140:143]
    s_waitcnt lgkmcnt(5)
    v_mfma_f32_16x16x32_bf16 v[4:7], v[192:195], v[216:219], v[4:7]
    ds_read_b128 v[228:231], v239 offset:8192
    v_mfma_f32_16x16x32_bf16 v[32:35], v[196:199], v[216:219], v[32:35]
    ds_read_b64_tr_b16 v[174:175], v236 offset:512
    v_mfma_f32_16x16x32_bf16 v[60:63], v[200:203], v[216:219], v[60:63]
    ds_read_b64_tr_b16 v[176:177], v237 offset:0
    v_mfma_f32_16x16x32_bf16 v[88:91], v[204:207], v[216:219], v[88:91]
    ds_read_b64_tr_b16 v[178:179], v237 offset:512
    v_mfma_f32_16x16x32_bf16 v[116:119], v[208:211], v[216:219], v[116:119]
    v_mfma_f32_16x16x32_bf16 v[144:147], v[212:215], v[216:219], v[144:147]
    s_waitcnt lgkmcnt(8)
    v_mfma_f32_16x16x32_bf16 v[8:11], v[192:195], v[220:223], v[8:11]
    ds_read_b128 v[216:219], v239 offset:10240
    v_mfma_f32_16x16x32_bf16 v[36:39], v[196:199], v[220:223], v[36:39]
    ds_read_b64_tr_b16 v[180:181], v235 offset:12288
    v_mfma_f32_16x16x32_bf16 v[64:67], v[200:203], v[220:223], v[64:67]
    ds_read_b64_tr_b16 v[182:183], v235 offset:12800
    v_mfma_f32_16x16x32_bf16 v[92:95], v[204:207], v[220:223], v[92:95]
    ds_read_b64_tr_b16 v[184:185], v236 offset:12288
    v_mfma_f32_16x16x32_bf16 v[120:123], v[208:211], v[220:223], v[120:123]
    v_mfma_f32_16x16x32_bf16 v[148:151], v[212:215], v[220:223], v[148:151]
    s_waitcnt lgkmcnt(11)
    v_mfma_f32_16x16x32_bf16 v[12:15], v[192:195], v[224:227], v[12:15]
    ds_read_b128 v[220:223], v239 offset:12288
    v_mfma_f32_16x16x32_bf16 v[40:43], v[196:199], v[224:227], v[40:43]
    ds_read_b64_tr_b16 v[186:187], v236 offset:12800
    v_mfma_f32_16x16x32_bf16 v[68:71], v[200:203], v[224:227], v[68:71]
    ds_read_b64_tr_b16 v[188:189], v237 offset:12288
    v_mfma_f32_16x16x32_bf16 v[96:99], v[204:207], v[224:227], v[96:99]
    ds_read_b64_tr_b16 v[190:191], v237 offset:12800
    v_mfma_f32_16x16x32_bf16 v[124:127], v[208:211], v[224:227], v[124:127]
    v_mfma_f32_16x16x32_bf16 v[152:155], v[212:215], v[224:227], v[152:155]
    s_waitcnt lgkmcnt(11)
    v_mfma_f32_16x16x32_bf16 v[16:19], v[192:195], v[228:231], v[16:19]
    ds_read_b128 v[224:227], v238 offset:0
    v_mfma_f32_16x16x32_bf16 v[44:47], v[196:199], v[228:231], v[44:47]
    v_add_u32 v239, s60, v241
    v_mfma_f32_16x16x32_bf16 v[72:75], v[200:203], v[228:231], v[72:75]
    v_mfma_f32_16x16x32_bf16 v[100:103], v[204:207], v[228:231], v[100:103]
    v_mfma_f32_16x16x32_bf16 v[128:131], v[208:211], v[228:231], v[128:131]
    v_mfma_f32_16x16x32_bf16 v[156:159], v[212:215], v[228:231], v[156:159]
    s_waitcnt lgkmcnt(8)
    v_mfma_f32_16x16x32_bf16 v[20:23], v[192:195], v[216:219], v[20:23]
    ds_read_b128 v[228:231], v238 offset:2048
    v_mfma_f32_16x16x32_bf16 v[48:51], v[196:199], v[216:219], v[48:51]
    s_waitcnt lgkmcnt(5)
    v_cndmask_b32 v220, v220, v242, s[64:65]
    v_cndmask_b32 v221, v221, v242, s[64:65]
    v_mfma_f32_16x16x32_bf16 v[76:79], v[200:203], v[216:219], v[76:79]
    v_cndmask_b32 v222, v222, v242, s[64:65]
    v_cndmask_b32 v223, v223, v242, s[64:65]
    v_mfma_f32_16x16x32_bf16 v[104:107], v[204:207], v[216:219], v[104:107]
    v_mfma_f32_16x16x32_bf16 v[132:135], v[208:211], v[216:219], v[132:135]
    v_mfma_f32_16x16x32_bf16 v[160:163], v[212:215], v[216:219], v[160:163]
    v_mfma_f32_16x16x32_bf16 v[24:27], v[192:195], v[220:223], v[24:27]
    ds_read_b128 v[216:219], v238 offset:4096
    v_mfma_f32_16x16x32_bf16 v[52:55], v[196:199], v[220:223], v[52:55]
    v_mfma_f32_16x16x32_bf16 v[80:83], v[200:203], v[220:223], v[80:83]
    v_mfma_f32_16x16x32_bf16 v[108:111], v[204:207], v[220:223], v[108:111]
    v_mfma_f32_16x16x32_bf16 v[136:139], v[208:211], v[220:223], v[136:139]
    v_mfma_f32_16x16x32_bf16 v[164:167], v[212:215], v[220:223], v[164:167]
    s_waitcnt lgkmcnt(2)
    v_mfma_f32_16x16x32_bf16 v[0:3], v[168:171], v[224:227], v[0:3]
    ds_read_b128 v[220:223], v238 offset:6144
    v_mfma_f32_16x16x32_bf16 v[28:31], v[172:175], v[224:227], v[28:31]
    s_cmp_eq_u32 s61, 4
    s_cbranch_scc1 cg_nb2
    s_barrier
cg_nb2:
    v_mfma_f32_16x16x32_bf16 v[56:59], v[176:179], v[224:227], v[56:59]
    ds_read_b64_tr_b16 v[192:193], v235 offset:24576
    v_mfma_f32_16x16x32_bf16 v[84:87], v[180:183], v[224:227], v[84:87]
    ds_read_b64_tr_b16 v[194:195], v235 offset:25088
    v_mfma_f32_16x16x32_bf16 v[112:115], v[184:187], v[224:227], v[112:115]
    ds_read_b64_tr_b16 v[196:197], v236 offset:24576
    v_mfma_f32_16x16x32_bf16 v[140:143], v[188:191], v[224:227], v[140:143]
    s_waitcnt lgkmcnt(5)
    v_mfma_f32_16x16x32_bf16 v[4:7], v[168:171], v[228:231], v[4:7]
    ds_read_b128 v[224:227], v238 offset:8192
    v_mfma_f32_16x16x32_bf16 v[32:35], v[172:175], v[228:231], v[32:35]
    ds_read_b64_tr_b16 v[198:199], v236 offset:25088
    v_mfma_f32_16x16x32_bf16 v[60:63], v[176:179], v[228:231], v[60:63]
    ds_read_b64_tr_b16 v[200:201], v237 offset:24576
    v_mfma_f32_16x16x32_bf16 v[88:91], v[180:183], v[228:231], v[88:91]
    ds_read_b64_tr_b16 v[202:203], v237 offset:25088
    v_mfma_f32_16x16x32_bf16 v[116:119], v[184:187], v[228:231], v[116:119]
    v_mfma_f32_16x16x32_bf16 v[144:147], v[188:191], v[228:231], v[144:147]
    s_waitcnt lgkmcnt(8)
    v_mfma_f32_16x16x32_bf16 v[8:11], v[168:171], v[216:219], v[8:11]
    ds_read_b128 v[228:231], v238 offset:10240
    v_mfma_f32_16x16x32_bf16 v[36:39], v[172:175], v[216:219], v[36:39]
    ds_read_b64_tr_b16 v[204:205], v235 offset:36864
    v_mfma_f32_16x16x32_bf16 v[64:67], v[176:179], v[216:219], v[64:67]
    ds_read_b64_tr_b16 v[206:207], v235 offset:37376
    v_mfma_f32_16x16x32_bf16 v[92:95], v[180:183], v[216:219], v[92:95]
    ds_read_b64_tr_b16 v[208:209], v236 offset:36864
    v_mfma_f32_16x16x32_bf16 v[120:123], v[184:187], v[216:219], v[120:123]
    v_mfma_f32_16x16x32_bf16 v[148:151], v[188:191], v[216:219], v[148:151]
    s_waitcnt lgkmcnt(11)
    v_mfma_f32_16x16x32_bf16 v[12:15], v[168:171], v[220:223], v[12:15]
    ds_read_b128 v[216:219], v238 offset:12288
    v_mfma_f32_16x16x32_bf16 v[40:43], v[172:175], v[220:223], v[40:43]
    ds_read_b64_tr_b16 v[210:211], v236 offset:37376
    v_mfma_f32_16x16x32_bf16 v[68:71], v[176:179], v[220:223], v[68:71]
    ds_read_b64_tr_b16 v[212:213], v237 offset:36864
    v_mfma_f32_16x16x32_bf16 v[96:99], v[180:183], v[220:223], v[96:99]
    ds_read_b64_tr_b16 v[214:215], v237 offset:37376
    v_mfma_f32_16x16x32_bf16 v[124:127], v[184:187], v[220:223], v[124:127]
    v_mfma_f32_16x16x32_bf16 v[152:155], v[188:191], v[220:223], v[152:155]
    s_waitcnt lgkmcnt(11)
    v_mfma_f32_16x16x32_bf16 v[16:19], v[168:171], v[224:227], v[16:19]
    ds_read_b128 v[220:223], v239 offset:0
    v_mfma_f32_16x16x32_bf16 v[44:47], v[172:175], v[224:227], v[44:47]
    s_add_u32 s60, s60, 14336
    s_cmp_ge_u32 s60, 43008
    v_mfma_f32_16x16x32_bf16 v[72:75], v[176:179], v[224:227], v[72:75]
    s_cselect_b32 s60, 0, s60
    v_add_u32 v238, s60, v240
    v_mfma_f32_16x16x32_bf16 v[100:103], v[180:183], v[224:227], v[100:103]
    v_mfma_f32_16x16x32_bf16 v[128:131], v[184:187], v[224:227], v[128:131]
    v_mfma_f32_16x16x32_bf16 v[156:159], v[188:191], v[224:227], v[156:159]
    s_waitcnt lgkmcnt(8)
    v_mfma_f32_16x16x32_bf16 v[20:23], v[168:171], v[228:231], v[20:23]
    ds_read_b128 v[224:227], v239 offset:2048
    v_mfma_f32_16x16x32_bf16 v[48:51], v[172:175], v[228:231], v[48:51]
    s_waitcnt lgkmcnt(5)
    v_cndmask_b32 v216, v216, v242, s[64:65]
    v_cndmask_b32 v217, v217, v242, s[64:65]
    v_mfma_f32_16x16x32_bf16 v[76:79], v[176:179], v[228:231], v[76:79]
    v_cndmask_b32 v218, v218, v242, s[64:65]
    v_cndmask_b32 v219, v219, v242, s[64:65]
    v_mfma_f32_16x16x32_bf16 v[104:107], v[180:183], v[228:231], v[104:107]
    v_mfma_f32_16x16x32_bf16 v[132:135], v[184:187], v[228:231], v[132:135]
    v_mfma_f32_16x16x32_bf16 v[160:163], v[188:191], v[228:231], v[160:163]
    v_mfma_f32_16x16x32_bf16 v[24:27], v[168:171], v[216:219], v[24:27]
    ds_read_b128 v[228:231], v239 offset:4096
    v_mfma_f32_16x16x32_bf16 v[52:55], v[172:175], v[216:219], v[52:55]
    v_mfma_f32_16x16x32_bf16 v[80:83], v[176:179], v[216:219], v[80:83]
    v_mfma_f32_16x16x32_bf16 v[108:111], v[180:183], v[216:219], v[108:111]
    v_mfma_f32_16x16x32_bf16 v[136:139], v[184:187], v[216:219], v[136:139]
    v_mfma_f32_16x16x32_bf16 v[164:167], v[188:191], v[216:219], v[164:167]
    s_waitcnt lgkmcnt(2)
    v_mfma_f32_16x16x32_bf16 v[0:3], v[192:195], v[220:223], v[0:3]
    ds_read_b128 v[216:219], v239 offset:6144
    v_mfma_f32_16x16x32_bf16 v[28:31], v[196:199], v[220:223], v[28:31]
    s_cmp_eq_u32 s61, 4
    s_cbranch_scc1 cg_nb3
    s_barrier
cg_nb3:
    v_mfma_f32_16x16x32_bf16 v[56:59], v[200:203], v[220:223], v[56:59]
    ds_read_b64_tr_b16 v[168:169], v232 offset:0
    v_mfma_f32_16x16x32_bf16 v[84:87], v[204:207], v[220:223], v[84:87]
    ds_read_b64_tr_b16 v[170:171], v232 offset:512
    v_mfma_f32_16x16x32_bf16 v[112:115], v[208:211], v[220:223], v[112:115]
    ds_read_b64_tr_b16 v[172:173], v233 offset:0
    v_mfma_f32_16x16x32_bf16 v[140:143], v[212:215], v[220:223], v[140:143]
    s_waitcnt lgkmcnt(5)
    v_mfma_f32_16x16x32_bf16 v[4:7], v[192:195], v[224:227], v[4:7]
    ds_read_b128 v[220:223], v239 offset:8192
    v_mfma_f32_16x16x32_bf16 v[32:35], v[196:199], v[224:227], v[32:35]
    ds_read_b64_tr_b16 v[174:175], v233 offset:512
    v_mfma_f32_16x16x32_bf16 v[60:63], v[200:203], v[224:227], v[60:63]
    ds_read_b64_tr_b16 v[176:177], v234 offset:0
    v_mfma_f32_16x16x32_bf16 v[88:91], v[204:207], v[224:227], v[88:91]
    ds_read_b64_tr_b16 v[178:179], v234 offset:512
    v_mfma_f32_16x16x32_bf16 v[116:119], v[208:211], v[224:227], v[116:119]
    v_mfma_f32_16x16x32_bf16 v[144:147], v[212:215], v[224:227], v[144:147]
    s_waitcnt lgkmcnt(8)
    v_mfma_f32_16x16x32_bf16 v[8:11], v[192:195], v[228:231], v[8:11]
    ds_read_b128 v[224:227], v239 offset:10240
    v_mfma_f32_16x16x32_bf16 v[36:39], v[196:199], v[228:231], v[36:39]
    ds_read_b64_tr_b16 v[180:181], v232 offset:12288
    v_mfma_f32_16x16x32_bf16 v[64:67], v[200:203], v[228:231], v[64:67]
    ds_read_b64_tr_b16 v[182:183], v232 offset:12800
    v_mfma_f32_16x16x32_bf16 v[92:95], v[204:207], v[228:231], v[92:95]
    ds_read_b64_tr_b16 v[184:185], v233 offset:12288
    v_mfma_f32_16x16x32_bf16 v[120:123], v[208:211], v[228:231], v[120:123]
    v_mfma_f32_16x16x32_bf16 v[148:151], v[212:215], v[228:231], v[148:151]
    s_waitcnt lgkmcnt(11)
    v_mfma_f32_16x16x32_bf16 v[12:15], v[192:195], v[216:219], v[12:15]
    ds_read_b128 v[228:231], v239 offset:12288
    v_mfma_f32_16x16x32_bf16 v[40:43], v[196:199], v[216:219], v[40:43]
    ds_read_b64_tr_b16 v[186:187], v233 offset:12800
    v_mfma_f32_16x16x32_bf16 v[68:71], v[200:203], v[216:219], v[68:71]
    ds_read_b64_tr_b16 v[188:189], v234 offset:12288
    v_mfma_f32_16x16x32_bf16 v[96:99], v[204:207], v[216:219], v[96:99]
    ds_read_b64_tr_b16 v[190:191], v234 offset:12800
    v_mfma_f32_16x16x32_bf16 v[124:127], v[208:211], v[216:219], v[124:127]
    v_mfma_f32_16x16x32_bf16 v[152:155], v[212:215], v[216:219], v[152:155]
    s_waitcnt lgkmcnt(11)
    v_mfma_f32_16x16x32_bf16 v[16:19], v[192:195], v[220:223], v[16:19]
    ds_read_b128 v[216:219], v238 offset:0
    v_mfma_f32_16x16x32_bf16 v[44:47], v[196:199], v[220:223], v[44:47]
    v_add_u32 v239, s60, v241
    v_mfma_f32_16x16x32_bf16 v[72:75], v[200:203], v[220:223], v[72:75]
    v_mfma_f32_16x16x32_bf16 v[100:103], v[204:207], v[220:223], v[100:103]
    v_mfma_f32_16x16x32_bf16 v[128:131], v[208:211], v[220:223], v[128:131]
    v_mfma_f32_16x16x32_bf16 v[156:159], v[212:215], v[220:223], v[156:159]
    s_waitcnt lgkmcnt(8)
    v_mfma_f32_16x16x32_bf16 v[20:23], v[192:195], v[224:227], v[20:23]
    ds_read_b128 v[220:223], v238 offset:2048
    v_mfma_f32_16x16x32_bf16 v[48:51], v[196:199], v[224:227], v[48:51]
    s_waitcnt lgkmcnt(5)
    v_cndmask_b32 v228, v228, v242, s[64:65]
    v_cndmask_b32 v229, v229, v242, s[64:65]
    v_mfma_f32_16x16x32_bf16 v[76:79], v[200:203], v[224:227], v[76:79]
    v_cndmask_b32 v230, v230, v242, s[64:65]
    v_cndmask_b32 v231, v231, v242, s[64:65]
    v_mfma_f32_16x16x32_bf16 v[104:107], v[204:207], v[224:227], v[104:107]
    s_add_u32 s61, s61, 1
    s_cmp_lt_u32 s61, 5
    v_mfma_f32_16x16x32_bf16 v[132:135], v[208:211], v[224:227], v[132:135]
    v_mfma_f32_16x16x32_bf16 v[160:163], v[212:215], v[224:227], v[160:163]
    v_mfma_f32_16x16x32_bf16 v[24:27], v[192:195], v[228:231], v[24:27]
    ds_read_b128 v[224:227], v238 offset:4096
    v_mfma_f32_16x16x32_bf16 v[52:55], v[196:199], v[228:231], v[52:55]
    v_mfma_f32_16x16x32_bf16 v[80:83], v[200:203], v[228:231], v[80:83]
    v_mfma_f32_16x16x32_bf16 v[108:111], v[204:207], v[228:231], v[108:111]
    v_mfma_f32_16x16x32_bf16 v[136:139], v[208:211], v[228:231], v[136:139]
    v_mfma_f32_16x16x32_bf16 v[164:167], v[212:215], v[228:231], v[164:167]
    s_cbranch_scc1 cg_loop
    s_waitcnt lgkmcnt(0)
    v_mov_b32 v246, 160260
    v_mov_b32 v247, 1
    s_mov_b64 exec, 1
    ds_add_u32 v246, v247
    s_mov_b64 exec, -1
    ds_read2_b32 v[232:233], v249 offset0:0 offset1:16
    ds_read2_b32 v[234:235], v249 offset0:32 offset1:48
    ds_read2_b32 v[236:237], v249 offset0:64 offset1:80
    ds_read2_b32 v[238:239], v249 offset0:96 offset1:112
    ds_read2_b32 v[244:245], v250 offset0:0 offset1:32
    ds_read2_b32 v[246:247], v250 offset0:64 offset1:96
    ds_read_b128 v[168:171], v248 offset:0
    ds_read_b128 v[172:175], v248 offset:256
    ds_read_b128 v[176:179], v248 offset:512
    ds_read_b128 v[180:183], v248 offset:768
    ds_read_b128 v[184:187], v248 offset:1024
    ds_read_b128 v[188:191], v248 offset:1280
    ds_read_b128 v[192:195], v248 offset:1536
    v_mov_b32_dpp v196, v24 row_newbcast:15 row_mask:0xf bank_mask:0xf
    v_mov_b32_dpp v197, v25 row_newbcast:15 row_mask:0xf bank_mask:0xf
    v_mov_b32_dpp v198, v26 row_newbcast:15 row_mask:0xf bank_mask:0xf
    v_mov_b32_dpp v199, v27 row_newbcast:15 row_mask:0xf bank_mask:0xf
    v_mov_b32_dpp v200, v52 row_newbcast:15 row_mask:0xf bank_mask:0xf
    v_mov_b32_dpp v201, v53 row_newbcast:15 row_mask:0xf bank_mask:0xf
    v_mov_b32_dpp v202, v54 row_newbcast:15 row_mask:0xf bank_mask:0xf
    v_mov_b32_dpp v203, v55 row_newbcast:15 row_mask:0xf bank_mask:0xf
    v_mov_b32_dpp v204, v80 row_newbcast:15 row_mask:0xf bank_mask:0xf
    v_mov_b32_dpp v205, v81 row_newbcast:15 row_mask:0xf bank_mask:0xf
    v_mov_b32_dpp v206, v82 row_newbcast:15 row_mask:0xf bank_mask:0xf
    v_mov_b32_dpp v207, v83 row_newbcast:15 row_mask:0xf bank_mask:0xf
    v_mov_b32_dpp v208, v108 row_newbcast:15 row_mask:0xf bank_mask:0xf
    v_mov_b32_dpp v209, v109 row_newbcast:15 row_mask:0xf bank_mask:0xf
    v_mov_b32_dpp v210, v110 row_newbcast:15 row_mask:0xf bank_mask:0xf
    v_mov_b32_dpp v211, v111 row_newbcast:15 row_mask:0xf bank_mask:0xf
    v_mov_b32_dpp v212, v136 row_newbcast:15 row_mask:0xf bank_mask:0xf
    v_mov_b32_dpp v213, v137 row_newbcast:15 row_mask:0xf bank_mask:0xf
    v_mov_b32_dpp v214, v138 row_newbcast:15 row_mask:0xf bank_mask:0xf
    v_mov_b32_dpp v215, v139 row_newbcast:15 row_mask:0xf bank_mask:0xf
    v_mov_b32_dpp v216, v164 row_newbcast:15 row_mask:0xf bank_mask:0xf
    v_mov_b32_dpp v217, v165 row_newbcast:15 row_mask:0xf bank_mask:0xf
    v_mov_b32_dpp v218, v166 row_newbcast:15 row_mask:0xf bank_mask:0xf
    v_mov_b32_dpp v219, v167 row_newbcast:15 row_mask:0xf bank_mask:0xf
    s_waitcnt lgkmcnt(6)
    v_pk_fma_f32 v[0:1], v[196:197], v[168:169], v[0:1] op_sel:[0,0,0] op_sel_hi:[1,0,1]
    v_pk_fma_f32 v[2:3], v[198:199], v[168:169], v[2:3] op_sel:[0,0,0] op_sel_hi:[1,0,1]
    v_pk_fma_f32 v[28:29], v[200:201], v[168:169], v[28:29] op_sel:[0,0,0] op_sel_hi:[1,0,1]
    v_pk_fma_f32 v[30:31], v[202:203], v[168:169], v[30:31] op_sel:[0,0,0] op_sel_hi:[1,0,1]
    v_pk_mul_f32 v[220:221], v[0:1], v[0:1]
    v_pk_mul_f32 v[222:223], v[2:3], v[2:3]
    v_pk_mul_f32 v[224:225], v[28:29], v[28:29]
    v_pk_mul_f32 v[226:227], v[30:31], v[30:31]
    v_pk_fma_f32 v[220:221], v[220:221], v[170:171], v[168:169] op_sel:[0,0,1] op_sel_hi:[1,0,1]
    v_pk_fma_f32 v[222:223], v[222:223], v[170:171], v[168:169] op_sel:[0,0,1] op_sel_hi:[1,0,1]
    v_pk_fma_f32 v[224:225], v[224:225], v[170:171], v[168:169] op_sel:[0,0,1] op_sel_hi:[1,0,1]
    v_pk_fma_f32 v[226:227], v[226:227], v[170:171], v[168:169] op_sel:[0,0,1] op_sel_hi:[1,0,1]
    v_pk_mul_f32 v[220:221], v[220:221], v[0:1]
    v_pk_mul_f32 v[222:223], v[222:223], v[2:3]
    v_pk_mul_f32 v[224:225], v[224:225], v[28:29]
    v_pk_mul_f32 v[226:227], v[226:227], v[30:31]
    v_exp_f32 v220, v220
    v_exp_f32 v221, v221
    v_pk_fma_f32 v[84:85], v[208:209], v[168:169], v[84:85] op_sel:[0,0,0] op_sel_hi:[1,0,1]
    v_exp_f32 v222, v222
    v_exp_f32 v223, v223
    v_pk_fma_f32 v[86:87], v[210:211], v[168:169], v[86:87] op_sel:[0,0,0] op_sel_hi:[1,0,1]
    v_exp_f32 v224, v224
    v_exp_f32 v225, v225
    v_pk_fma_f32 v[112:113], v[212:213], v[168:169], v[112:113] op_sel:[0,0,0] op_sel_hi:[1,0,1]
    v_exp_f32 v226, v226
    v_exp_f32 v227, v227
    v_pk_fma_f32 v[114:115], v[214:215], v[168:169], v[114:115] op_sel:[0,0,0] op_sel_hi:[1,0,1]
    v_pk_fma_f32 v[220:221], v[220:221], v[170:171], v[170:171] op_sel:[0,1,1] op_sel_hi:[1,1,1]
    v_pk_fma_f32 v[222:223], v[222:223], v[170:171], v[170:171] op_sel:[0,1,1] op_sel_hi:[1,1,1]
    v_pk_fma_f32 v[224:225], v[224:225], v[170:171], v[170:171] op_sel:[0,1,1] op_sel_hi:[1,1,1]
    v_pk_fma_f32 v[226:227], v[226:227], v[170:171], v[170:171] op_sel:[0,1,1] op_sel_hi:[1,1,1]
    v_rcp_f32 v220, v220
    v_rcp_f32 v221, v221
    v_pk_mul_f32 v[84:85], v[84:85], v[0:1]
    v_rcp_f32 v222, v222
    v_rcp_f32 v223, v223
    v_pk_mul_f32 v[86:87], v[86:87], v[2:3]
    v_rcp_f32 v224, v224
    v_rcp_f32 v225, v225
    v_pk_mul_f32 v[112:113], v[112:113], v[28:29]
    v_rcp_f32 v226, v226
    v_rcp_f32 v227, v227
    v_pk_mul_f32 v[114:115], v[114:115], v[30:31]
    v_pk_mul_f32 v[84:85], v[84:85], v[220:221]
    v_pk_mul_f32 v[86:87], v[86:87], v[222:223]
    v_pk_mul_f32 v[112:113], v[112:113], v[224:225]
    v_pk_mul_f32 v[114:115], v[114:115], v[226:227]
    v_cvt_pk_bf16_f32 v0, v84, v85
    v_cvt_pk_bf16_f32 v1, v86, v87
    v_cvt_pk_bf16_f32 v2, v112, v113
    v_cvt_pk_bf16_f32 v3, v114, v115
    v_add_u32 v28, v232, v251
    buffer_store_dwordx4 v[0:3], v28, s[36:39], 0 offen sc1
    s_waitcnt lgkmcnt(5)
    v_pk_fma_f32 v[4:5], v[196:197], v[172:173], v[4:5] op_sel:[0,0,0] op_sel_hi:[1,0,1]
    v_pk_fma_f32 v[6:7], v[198:199], v[172:173], v[6:7] op_sel:[0,0,0] op_sel_hi:[1,0,1]
    v_pk_fma_f32 v[32:33], v[200:201], v[172:173], v[32:33] op_sel:[0,0,0] op_sel_hi:[1,0,1]
    v_pk_fma_f32 v[34:35], v[202:203], v[172:173], v[34:35] op_sel:[0,0,0] op_sel_hi:[1,0,1]
    v_pk_mul_f32 v[220:221], v[4:5], v[4:5]
    v_pk_mul_f32 v[222:223], v[6:7], v[6:7]
    v_pk_mul_f32 v[224:225], v[32:33], v[32:33]
    v_pk_mul_f32 v[226:227], v[34:35], v[34:35]
    v_pk_fma_f32 v[220:221], v[220:221], v[174:175], v[172:173] op_sel:[0,0,1] op_sel_hi:[1,0,1]
    v_pk_fma_f32 v[222:223], v[222:223], v[174:175], v[172:173] op_sel:[0,0,1] op_sel_hi:[1,0,1]
    v_pk_fma_f32 v[224:225], v[224:225], v[174:175], v[172:173] op_sel:[0,0,1] op_sel_hi:[1,0,1]
    v_pk_fma_f32 v[226:227], v[226:227], v[174:175], v[172:173] op_sel:[0,0,1] op_sel_hi:[1,0,1]
    v_pk_mul_f32 v[220:221], v[220:221], v[4:5]
    v_pk_mul_f32 v[222:223], v[222:223], v[6:7]
    v_pk_mul_f32 v[224:225], v[224:225], v[32:33]
    v_pk_mul_f32 v[226:227], v[226:227], v[34:35]
    v_exp_f32 v220, v220
    v_exp_f32 v221, v221
    v_pk_fma_f32 v[88:89], v[208:209], v[172:173], v[88:89] op_sel:[0,0,0] op_sel_hi:[1,0,1]
    v_exp_f32 v222, v222
    v_exp_f32 v223, v223
    v_pk_fma_f32 v[90:91], v[210:211], v[172:173], v[90:91] op_sel:[0,0,0] op_sel_hi:[1,0,1]
    v_exp_f32 v224, v224
    v_exp_f32 v225, v225
    v_pk_fma_f32 v[116:117], v[212:213], v[172:173], v[116:117] op_sel:[0,0,0] op_sel_hi:[1,0,1]
    v_exp_f32 v226, v226
    v_exp_f32 v227, v227
    v_pk_fma_f32 v[118:119], v[214:215], v[172:173], v[118:119] op_sel:[0,0,0] op_sel_hi:[1,0,1]
    v_pk_fma_f32 v[220:221], v[220:221], v[174:175], v[174:175] op_sel:[0,1,1] op_sel_hi:[1,1,1]
    v_pk_fma_f32 v[222:223], v[222:223], v[174:175], v[174:175] op_sel:[0,1,1] op_sel_hi:[1,1,1]
    v_pk_fma_f32 v[224:225], v[224:225], v[174:175], v[174:175] op_sel:[0,1,1] op_sel_hi:[1,1,1]
    v_pk_fma_f32 v[226:227], v[226:227], v[174:175], v[174:175] op_sel:[0,1,1] op_sel_hi:[1,1,1]
    v_rcp_f32 v220, v220
    v_rcp_f32 v221, v221
    v_pk_mul_f32 v[88:89], v[88:89], v[4:5]
    v_rcp_f32 v222, v222
    v_rcp_f32 v223, v223
    v_pk_mul_f32 v[90:91], v[90:91], v[6:7]
    v_rcp_f32 v224, v224
    v_rcp_f32 v225, v225
    v_pk_mul_f32 v[116:117], v[116:117], v[32:33]
    v_rcp_f32 v226, v226
    v_rcp_f32 v227, v227
    v_pk_mul_f32 v[118:119], v[118:119], v[34:35]
    v_pk_mul_f32 v[88:89], v[88:89], v[220:221]
    v_pk_mul_f32 v[90:91], v[90:91], v[222:223]
    v_pk_mul_f32 v[116:117], v[116:117], v[224:225]
    v_pk_mul_f32 v[118:119], v[118:119], v[226:227]
    v_cvt_pk_bf16_f32 v4, v88, v89
    v_cvt_pk_bf16_f32 v5, v90, v91
    v_cvt_pk_bf16_f32 v6, v116, v117
    v_cvt_pk_bf16_f32 v7, v118, v119
    v_add_u32 v32, v233, v251
    buffer_store_dwordx4 v[4:7], v32, s[36:39], 0 offen sc1
    s_waitcnt lgkmcnt(4)
    v_pk_fma_f32 v[8:9], v[196:197], v[176:177], v[8:9] op_sel:[0,0,0] op_sel_hi:[1,0,1]
    v_pk_fma_f32 v[10:11], v[198:199], v[176:177], v[10:11] op_sel:[0,0,0] op_sel_hi:[1,0,1]
    v_pk_fma_f32 v[36:37], v[200:201], v[176:177], v[36:37] op_sel:[0,0,0] op_sel_hi:[1,0,1]
    v_pk_fma_f32 v[38:39], v[202:203], v[176:177], v[38:39] op_sel:[0,0,0] op_sel_hi:[1,0,1]
    v_pk_mul_f32 v[220:221], v[8:9], v[8:9]
    v_pk_mul_f32 v[222:223], v[10:11], v[10:11]
    v_pk_mul_f32 v[224:225], v[36:37], v[36:37]
    v_pk_mul_f32 v[226:227], v[38:39], v[38:39]
    v_pk_fma_f32 v[220:221], v[220:221], v[178:179], v[176:177] op_sel:[0,0,1] op_sel_hi:[1,0,1]
    v_pk_fma_f32 v[222:223], v[222:223], v[178:179], v[176:177] op_sel:[0,0,1] op_sel_hi:[1,0,1]
    v_pk_fma_f32 v[224:225], v[224:225], v[178:179], v[176:177] op_sel:[0,0,1] op_sel_hi:[1,0,1]
    v_pk_fma_f32 v[226:227], v[226:227], v[178:179], v[176:177] op_sel:[0,0,1] op_sel_hi:[1,0,1]
    v_pk_mul_f32 v[220:221], v[220:221], v[8:9]
    v_pk_mul_f32 v[222:223], v[222:223], v[10:11]
    v_pk_mul_f32 v[224:225], v[224:225], v[36:37]
    v_pk_mul_f32 v[226:227], v[226:227], v[38:39]
    v_exp_f32 v220, v220
    v_exp_f32 v221, v221
    v_pk_fma_f32 v[92:93], v[208:209], v[176:177], v[92:93] op_sel:[0,0,0] op_sel_hi:[1,0,1]
    v_exp_f32 v222, v222
    v_exp_f32 v223, v223
    v_pk_fma_f32 v[94:95], v[210:211], v[176:177], v[94:95] op_sel:[0,0,0] op_sel_hi:[1,0,1]
    v_exp_f32 v224, v224
    v_exp_f32 v225, v225
    v_pk_fma_f32 v[120:121], v[212:213], v[176:177], v[120:121] op_sel:[0,0,0] op_sel_hi:[1,0,1]
    v_exp_f32 v226, v226
    v_exp_f32 v227, v227
    v_pk_fma_f32 v[122:123], v[214:215], v[176:177], v[122:123] op_sel:[0,0,0] op_sel_hi:[1,0,1]
    v_pk_fma_f32 v[220:221], v[220:221], v[178:179], v[178:179] op_sel:[0,1,1] op_sel_hi:[1,1,1]
    v_pk_fma_f32 v[222:223], v[222:223], v[178:179], v[178:179] op_sel:[0,1,1] op_sel_hi:[1,1,1]
    v_pk_fma_f32 v[224:225], v[224:225], v[178:179], v[178:179] op_sel:[0,1,1] op_sel_hi:[1,1,1]
    v_pk_fma_f32 v[226:227], v[226:227], v[178:179], v[178:179] op_sel:[0,1,1] op_sel_hi:[1,1,1]
    v_rcp_f32 v220, v220
    v_rcp_f32 v221, v221
    v_pk_mul_f32 v[92:93], v[92:93], v[8:9]
    v_rcp_f32 v222, v222
    v_rcp_f32 v223, v223
    v_pk_mul_f32 v[94:95], v[94:95], v[10:11]
    v_rcp_f32 v224, v224
    v_rcp_f32 v225, v225
    v_pk_mul_f32 v[120:121], v[120:121], v[36:37]
    v_rcp_f32 v226, v226
    v_rcp_f32 v227, v227
    v_pk_mul_f32 v[122:123], v[122:123], v[38:39]
    v_pk_mul_f32 v[92:93], v[92:93], v[220:221]
    v_pk_mul_f32 v[94:95], v[94:95], v[222:223]
    v_pk_mul_f32 v[120:121], v[120:121], v[224:225]
    v_pk_mul_f32 v[122:123], v[122:123], v[226:227]
    v_cvt_pk_bf16_f32 v8, v92, v93
    v_cvt_pk_bf16_f32 v9, v94, v95
    v_cvt_pk_bf16_f32 v10, v120, v121
    v_cvt_pk_bf16_f32 v11, v122, v123
    v_add_u32 v36, v234, v251
    buffer_store_dwordx4 v[8:11], v36, s[36:39], 0 offen sc1
    s_waitcnt lgkmcnt(3)
    v_pk_fma_f32 v[12:13], v[196:197], v[180:181], v[12:13] op_sel:[0,0,0] op_sel_hi:[1,0,1]
    v_pk_fma_f32 v[14:15], v[198:199], v[180:181], v[14:15] op_sel:[0,0,0] op_sel_hi:[1,0,1]
    v_pk_fma_f32 v[40:41], v[200:201], v[180:181], v[40:41] op_sel:[0,0,0] op_sel_hi:[1,0,1]
    v_pk_fma_f32 v[42:43], v[202:203], v[180:181], v[42:43] op_sel:[0,0,0] op_sel_hi:[1,0,1]
    v_pk_mul_f32 v[220:221], v[12:13], v[12:13]
    v_pk_mul_f32 v[222:223], v[14:15], v[14:15]
    v_pk_mul_f32 v[224:225], v[40:41], v[40:41]
    v_pk_mul_f32 v[226:227], v[42:43], v[42:43]
    v_pk_fma_f32 v[220:221], v[220:221], v[182:183], v[180:181] op_sel:[0,0,1] op_sel_hi:[1,0,1]
    v_pk_fma_f32 v[222:223], v[222:223], v[182:183], v[180:181] op_sel:[0,0,1] op_sel_hi:[1,0,1]
    v_pk_fma_f32 v[224:225], v[224:225], v[182:183], v[180:181] op_sel:[0,0,1] op_sel_hi:[1,0,1]
    v_pk_fma_f32 v[226:227], v[226:227], v[182:183], v[180:181] op_sel:[0,0,1] op_sel_hi:[1,0,1]
    v_pk_mul_f32 v[220:221], v[220:221], v[12:13]
    v_pk_mul_f32 v[222:223], v[222:223], v[14:15]
    v_pk_mul_f32 v[224:225], v[224:225], v[40:41]
    v_pk_mul_f32 v[226:227], v[226:227], v[42:43]
    v_exp_f32 v220, v220
    v_exp_f32 v221, v221
    v_pk_fma_f32 v[96:97], v[208:209], v[180:181], v[96:97] op_sel:[0,0,0] op_sel_hi:[1,0,1]
    v_exp_f32 v222, v222
    v_exp_f32 v223, v223
    v_pk_fma_f32 v[98:99], v[210:211], v[180:181], v[98:99] op_sel:[0,0,0] op_sel_hi:[1,0,1]
    v_exp_f32 v224, v224
    v_exp_f32 v225, v225
    v_pk_fma_f32 v[124:125], v[212:213], v[180:181], v[124:125] op_sel:[0,0,0] op_sel_hi:[1,0,1]
    v_exp_f32 v226, v226
    v_exp_f32 v227, v227
    v_pk_fma_f32 v[126:127], v[214:215], v[180:181], v[126:127] op_sel:[0,0,0] op_sel_hi:[1,0,1]
    v_pk_fma_f32 v[220:221], v[220:221], v[182:183], v[182:183] op_sel:[0,1,1] op_sel_hi:[1,1,1]
    v_pk_fma_f32 v[222:223], v[222:223], v[182:183], v[182:183] op_sel:[0,1,1] op_sel_hi:[1,1,1]
    v_pk_fma_f32 v[224:225], v[224:225], v[182:183], v[182:183] op_sel:[0,1,1] op_sel_hi:[1,1,1]
    v_pk_fma_f32 v[226:227], v[226:227], v[182:183], v[182:183] op_sel:[0,1,1] op_sel_hi:[1,1,1]
    v_rcp_f32 v220, v220
    v_rcp_f32 v221, v221
    v_pk_mul_f32 v[96:97], v[96:97], v[12:13]
    v_rcp_f32 v222, v222
    v_rcp_f32 v223, v223
    v_pk_mul_f32 v[98:99], v[98:99], v[14:15]
    v_rcp_f32 v224, v224
    v_rcp_f32 v225, v225
    v_pk_mul_f32 v[124:125], v[124:125], v[40:41]
    v_rcp_f32 v226, v226
    v_rcp_f32 v227, v227
    v_pk_mul_f32 v[126:127], v[126:127], v[42:43]
    v_pk_mul_f32 v[96:97], v[96:97], v[220:221]
    v_pk_mul_f32 v[98:99], v[98:99], v[222:223]
    v_pk_mul_f32 v[124:125], v[124:125], v[224:225]
    v_pk_mul_f32 v[126:127], v[126:127], v[226:227]
    v_cvt_pk_bf16_f32 v12, v96, v97
    v_cvt_pk_bf16_f32 v13, v98, v99
    v_cvt_pk_bf16_f32 v14, v124, v125
    v_cvt_pk_bf16_f32 v15, v126, v127
    v_add_u32 v40, v235, v251
    buffer_store_dwordx4 v[12:15], v40, s[36:39], 0 offen sc1
    s_waitcnt lgkmcnt(2)
    v_pk_fma_f32 v[16:17], v[196:197], v[184:185], v[16:17] op_sel:[0,0,0] op_sel_hi:[1,0,1]
    v_pk_fma_f32 v[18:19], v[198:199], v[184:185], v[18:19] op_sel:[0,0,0] op_sel_hi:[1,0,1]
    v_pk_fma_f32 v[44:45], v[200:201], v[184:185], v[44:45] op_sel:[0,0,0] op_sel_hi:[1,0,1]
    v_pk_fma_f32 v[46:47], v[202:203], v[184:185], v[46:47] op_sel:[0,0,0] op_sel_hi:[1,0,1]
    v_pk_mul_f32 v[220:221], v[16:17], v[16:17]
    v_pk_mul_f32 v[222:223], v[18:19], v[18:19]
    v_pk_mul_f32 v[224:225], v[44:45], v[44:45]
    v_pk_mul_f32 v[226:227], v[46:47], v[46:47]
    v_pk_fma_f32 v[220:221], v[220:221], v[186:187], v[184:185] op_sel:[0,0,1] op_sel_hi:[1,0,1]
    v_pk_fma_f32 v[222:223], v[222:223], v[186:187], v[184:185] op_sel:[0,0,1] op_sel_hi:[1,0,1]
    v_pk_fma_f32 v[224:225], v[224:225], v[186:187], v[184:185] op_sel:[0,0,1] op_sel_hi:[1,0,1]
    v_pk_fma_f32 v[226:227], v[226:227], v[186:187], v[184:185] op_sel:[0,0,1] op_sel_hi:[1,0,1]
    v_pk_mul_f32 v[220:221], v[220:221], v[16:17]
    v_pk_mul_f32 v[222:223], v[222:223], v[18:19]
    v_pk_mul_f32 v[224:225], v[224:225], v[44:45]
    v_pk_mul_f32 v[226:227], v[226:227], v[46:47]
    v_exp_f32 v220, v220
    v_exp_f32 v221, v221
    v_pk_fma_f32 v[100:101], v[208:209], v[184:185], v[100:101] op_sel:[0,0,0] op_sel_hi:[1,0,1]
    v_exp_f32 v222, v222
    v_exp_f32 v223, v223
    v_pk_fma_f32 v[102:103], v[210:211], v[184:185], v[102:103] op_sel:[0,0,0] op_sel_hi:[1,0,1]
    v_exp_f32 v224, v224
    v_exp_f32 v225, v225
    v_pk_fma_f32 v[128:129], v[212:213], v[184:185], v[128:129] op_sel:[0,0,0] op_sel_hi:[1,0,1]
    v_exp_f32 v226, v226
    v_exp_f32 v227, v227
    v_pk_fma_f32 v[130:131], v[214:215], v[184:185], v[130:131] op_sel:[0,0,0] op_sel_hi:[1,0,1]
    v_pk_fma_f32 v[220:221], v[220:221], v[186:187], v[186:187] op_sel:[0,1,1] op_sel_hi:[1,1,1]
    v_pk_fma_f32 v[222:223], v[222:223], v[186:187], v[186:187] op_sel:[0,1,1] op_sel_hi:[1,1,1]
    v_pk_fma_f32 v[224:225], v[224:225], v[186:187], v[186:187] op_sel:[0,1,1] op_sel_hi:[1,1,1]
    v_pk_fma_f32 v[226:227], v[226:227], v[186:187], v[186:187] op_sel:[0,1,1] op_sel_hi:[1,1,1]
    v_rcp_f32 v220, v220
    v_rcp_f32 v221, v221
    v_pk_mul_f32 v[100:101], v[100:101], v[16:17]
    v_rcp_f32 v222, v222
    v_rcp_f32 v223, v223
    v_pk_mul_f32 v[102:103], v[102:103], v[18:19]
    v_rcp_f32 v224, v224
    v_rcp_f32 v225, v225
    v_pk_mul_f32 v[128:129], v[128:129], v[44:45]
    v_rcp_f32 v226, v226
    v_rcp_f32 v227, v227
    v_pk_mul_f32 v[130:131], v[130:131], v[46:47]
    v_pk_mul_f32 v[100:101], v[100:101], v[220:221]
    v_pk_mul_f32 v[102:103], v[102:103], v[222:223]
    v_pk_mul_f32 v[128:129], v[128:129], v[224:225]
    v_pk_mul_f32 v[130:131], v[130:131], v[226:227]
    v_cvt_pk_bf16_f32 v16, v100, v101
    v_cvt_pk_bf16_f32 v17, v102, v103
    v_cvt_pk_bf16_f32 v18, v128, v129
    v_cvt_pk_bf16_f32 v19, v130, v131
    v_add_u32 v44, v236, v251
    buffer_store_dwordx4 v[16:19], v44, s[36:39], 0 offen sc1
    s_waitcnt lgkmcnt(1)
    v_pk_fma_f32 v[20:21], v[196:197], v[188:189], v[20:21] op_sel:[0,0,0] op_sel_hi:[1,0,1]
    v_pk_fma_f32 v[22:23], v[198:199], v[188:189], v[22:23] op_sel:[0,0,0] op_sel_hi:[1,0,1]
    v_pk_fma_f32 v[48:49], v[200:201], v[188:189], v[48:49] op_sel:[0,0,0] op_sel_hi:[1,0,1]
    v_pk_fma_f32 v[50:51], v[202:203], v[188:189], v[50:51] op_sel:[0,0,0] op_sel_hi:[1,0,1]
    v_pk_mul_f32 v[220:221], v[20:21], v[20:21]
    v_pk_mul_f32 v[222:223], v[22:23], v[22:23]
    v_pk_mul_f32 v[224:225], v[48:49], v[48:49]
    v_pk_mul_f32 v[226:227], v[50:51], v[50:51]
    v_pk_fma_f32 v[220:221], v[220:221], v[190:191], v[188:189] op_sel:[0,0,1] op_sel_hi:[1,0,1]
    v_pk_fma_f32 v[222:223], v[222:223], v[190:191], v[188:189] op_sel:[0,0,1] op_sel_hi:[1,0,1]
    v_pk_fma_f32 v[224:225], v[224:225], v[190:191], v[188:189] op_sel:[0,0,1] op_sel_hi:[1,0,1]
    v_pk_fma_f32 v[226:227], v[226:227], v[190:191], v[188:189] op_sel:[0,0,1] op_sel_hi:[1,0,1]
    v_pk_mul_f32 v[220:221], v[220:221], v[20:21]
    v_pk_mul_f32 v[222:223], v[222:223], v[22:23]
    v_pk_mul_f32 v[224:225], v[224:225], v[48:49]
    v_pk_mul_f32 v[226:227], v[226:227], v[50:51]
    v_exp_f32 v220, v220
    v_exp_f32 v221, v221
    v_pk_fma_f32 v[104:105], v[208:209], v[188:189], v[104:105] op_sel:[0,0,0] op_sel_hi:[1,0,1]
    v_exp_f32 v222, v222
    v_exp_f32 v223, v223
    v_pk_fma_f32 v[106:107], v[210:211], v[188:189], v[106:107] op_sel:[0,0,0] op_sel_hi:[1,0,1]
    v_exp_f32 v224, v224
    v_exp_f32 v225, v225
    v_pk_fma_f32 v[132:133], v[212:213], v[188:189], v[132:133] op_sel:[0,0,0] op_sel_hi:[1,0,1]
    v_exp_f32 v226, v226
    v_exp_f32 v227, v227
    v_pk_fma_f32 v[134:135], v[214:215], v[188:189], v[134:135] op_sel:[0,0,0] op_sel_hi:[1,0,1]
    v_pk_fma_f32 v[220:221], v[220:221], v[190:191], v[190:191] op_sel:[0,1,1] op_sel_hi:[1,1,1]
    v_pk_fma_f32 v[222:223], v[222:223], v[190:191], v[190:191] op_sel:[0,1,1] op_sel_hi:[1,1,1]
    v_pk_fma_f32 v[224:225], v[224:225], v[190:191], v[190:191] op_sel:[0,1,1] op_sel_hi:[1,1,1]
    v_pk_fma_f32 v[226:227], v[226:227], v[190:191], v[190:191] op_sel:[0,1,1] op_sel_hi:[1,1,1]
    v_rcp_f32 v220, v220
    v_rcp_f32 v221, v221
    v_pk_mul_f32 v[104:105], v[104:105], v[20:21]
    v_rcp_f32 v222, v222
    v_rcp_f32 v223, v223
    v_pk_mul_f32 v[106:107], v[106:107], v[22:23]
    v_rcp_f32 v224, v224
    v_rcp_f32 v225, v225
    v_pk_mul_f32 v[132:133], v[132:133], v[48:49]
    v_rcp_f32 v226, v226
    v_rcp_f32 v227, v227
    v_pk_mul_f32 v[134:135], v[134:135], v[50:51]
    v_pk_mul_f32 v[104:105], v[104:105], v[220:221]
    v_pk_mul_f32 v[106:107], v[106:107], v[222:223]
    v_pk_mul_f32 v[132:133], v[132:133], v[224:225]
    v_pk_mul_f32 v[134:135], v[134:135], v[226:227]
    v_cvt_pk_bf16_f32 v20, v104, v105
    v_cvt_pk_bf16_f32 v21, v106, v107
    v_cvt_pk_bf16_f32 v22, v132, v133
    v_cvt_pk_bf16_f32 v23, v134, v135
    v_add_u32 v48, v237, v251
    buffer_store_dwordx4 v[20:23], v48, s[36:39], 0 offen sc1
    s_waitcnt lgkmcnt(0)
    v_pk_fma_f32 v[24:25], v[196:197], v[192:193], v[24:25] op_sel:[0,0,0] op_sel_hi:[1,0,1]
    v_pk_fma_f32 v[26:27], v[198:199], v[192:193], v[26:27] op_sel:[0,0,0] op_sel_hi:[1,0,1]
    v_pk_fma_f32 v[52:53], v[200:201], v[192:193], v[52:53] op_sel:[0,0,0] op_sel_hi:[1,0,1]
    v_pk_fma_f32 v[54:55], v[202:203], v[192:193], v[54:55] op_sel:[0,0,0] op_sel_hi:[1,0,1]
    v_pk_mul_f32 v[220:221], v[24:25], v[24:25]
    v_pk_mul_f32 v[222:223], v[26:27], v[26:27]
    v_pk_mul_f32 v[224:225], v[52:53], v[52:53]
    v_pk_mul_f32 v[226:227], v[54:55], v[54:55]
    v_pk_fma_f32 v[220:221], v[220:221], v[194:195], v[192:193] op_sel:[0,0,1] op_sel_hi:[1,0,1]
    v_pk_fma_f32 v[222:223], v[222:223], v[194:195], v[192:193] op_sel:[0,0,1] op_sel_hi:[1,0,1]
    v_pk_fma_f32 v[224:225], v[224:225], v[194:195], v[192:193] op_sel:[0,0,1] op_sel_hi:[1,0,1]
    v_pk_fma_f32 v[226:227], v[226:227], v[194:195], v[192:193] op_sel:[0,0,1] op_sel_hi:[1,0,1]
    v_pk_mul_f32 v[220:221], v[220:221], v[24:25]
    v_pk_mul_f32 v[222:223], v[222:223], v[26:27]
    v_pk_mul_f32 v[224:225], v[224:225], v[52:53]
    v_pk_mul_f32 v[226:227], v[226:227], v[54:55]
    v_exp_f32 v220, v220
    v_exp_f32 v221, v221
    v_pk_fma_f32 v[108:109], v[208:209], v[192:193], v[108:109] op_sel:[0,0,0] op_sel_hi:[1,0,1]
    v_exp_f32 v222, v222
    v_exp_f32 v223, v223
    v_pk_fma_f32 v[110:111], v[210:211], v[192:193], v[110:111] op_sel:[0,0,0] op_sel_hi:[1,0,1]
    v_exp_f32 v224, v224
    v_exp_f32 v225, v225
    v_pk_fma_f32 v[136:137], v[212:213], v[192:193], v[136:137] op_sel:[0,0,0] op_sel_hi:[1,0,1]
    v_exp_f32 v226, v226
    v_exp_f32 v227, v227
    v_pk_fma_f32 v[138:139], v[214:215], v[192:193], v[138:139] op_sel:[0,0,0] op_sel_hi:[1,0,1]
    v_pk_fma_f32 v[220:221], v[220:221], v[194:195], v[194:195] op_sel:[0,1,1] op_sel_hi:[1,1,1]
    v_pk_fma_f32 v[222:223], v[222:223], v[194:195], v[194:195] op_sel:[0,1,1] op_sel_hi:[1,1,1]
    v_pk_fma_f32 v[224:225], v[224:225], v[194:195], v[194:195] op_sel:[0,1,1] op_sel_hi:[1,1,1]
    v_pk_fma_f32 v[226:227], v[226:227], v[194:195], v[194:195] op_sel:[0,1,1] op_sel_hi:[1,1,1]
    v_rcp_f32 v220, v220
    v_rcp_f32 v221, v221
    v_pk_mul_f32 v[108:109], v[108:109], v[24:25]
    v_rcp_f32 v222, v222
    v_rcp_f32 v223, v223
    v_pk_mul_f32 v[110:111], v[110:111], v[26:27]
    v_rcp_f32 v224, v224
    v_rcp_f32 v225, v225
    v_pk_mul_f32 v[136:137], v[136:137], v[52:53]
    v_rcp_f32 v226, v226
    v_rcp_f32 v227, v227
    v_pk_mul_f32 v[138:139], v[138:139], v[54:55]
    v_pk_mul_f32 v[108:109], v[108:109], v[220:221]
    v_pk_mul_f32 v[110:111], v[110:111], v[222:223]
    v_pk_mul_f32 v[136:137], v[136:137], v[224:225]
    v_pk_mul_f32 v[138:139], v[138:139], v[226:227]
    v_cvt_pk_bf16_f32 v24, v108, v109
    v_cvt_pk_bf16_f32 v25, v110, v111
    v_cvt_pk_bf16_f32 v26, v136, v137
    v_cvt_pk_bf16_f32 v27, v138, v139
    v_add_u32 v52, v238, v251
    buffer_store_dwordx4 v[24:27], v52, s[36:39], 0 offen sc1
    v_pk_fma_f32 v[56:57], v[204:205], v[168:169], v[56:57] op_sel:[0,0,0] op_sel_hi:[1,0,1]
    v_pk_fma_f32 v[58:59], v[206:207], v[168:169], v[58:59] op_sel:[0,0,0] op_sel_hi:[1,0,1]
    v_pk_fma_f32 v[60:61], v[204:205], v[172:173], v[60:61] op_sel:[0,0,0] op_sel_hi:[1,0,1]
    v_pk_fma_f32 v[62:63], v[206:207], v[172:173], v[62:63] op_sel:[0,0,0] op_sel_hi:[1,0,1]
    v_pk_mul_f32 v[220:221], v[56:57], v[56:57]
    v_pk_mul_f32 v[222:223], v[58:59], v[58:59]
    v_pk_mul_f32 v[224:225], v[60:61], v[60:61]
    v_pk_mul_f32 v[226:227], v[62:63], v[62:63]
    v_pk_fma_f32 v[220:221], v[220:221], v[170:171], v[168:169] op_sel:[0,0,1] op_sel_hi:[1,0,1]
    v_pk_fma_f32 v[222:223], v[222:223], v[170:171], v[168:169] op_sel:[0,0,1] op_sel_hi:[1,0,1]
    v_pk_fma_f32 v[224:225], v[224:225], v[174:175], v[172:173] op_sel:[0,0,1] op_sel_hi:[1,0,1]
    v_pk_fma_f32 v[226:227], v[226:227], v[174:175], v[172:173] op_sel:[0,0,1] op_sel_hi:[1,0,1]
    v_pk_mul_f32 v[220:221], v[220:221], v[56:57]
    v_pk_mul_f32 v[222:223], v[222:223], v[58:59]
    v_pk_mul_f32 v[224:225], v[224:225], v[60:61]
    v_pk_mul_f32 v[226:227], v[226:227], v[62:63]
    v_exp_f32 v220, v220
    v_exp_f32 v221, v221
    v_pk_fma_f32 v[140:141], v[216:217], v[168:169], v[140:141] op_sel:[0,0,0] op_sel_hi:[1,0,1]
    v_exp_f32 v222, v222
    v_exp_f32 v223, v223
    v_pk_fma_f32 v[142:143], v[218:219], v[168:169], v[142:143] op_sel:[0,0,0] op_sel_hi:[1,0,1]
    v_exp_f32 v224, v224
    v_exp_f32 v225, v225
    v_pk_fma_f32 v[144:145], v[216:217], v[172:173], v[144:145] op_sel:[0,0,0] op_sel_hi:[1,0,1]
    v_exp_f32 v226, v226
    v_exp_f32 v227, v227
    v_pk_fma_f32 v[146:147], v[218:219], v[172:173], v[146:147] op_sel:[0,0,0] op_sel_hi:[1,0,1]
    v_pk_fma_f32 v[220:221], v[220:221], v[170:171], v[170:171] op_sel:[0,1,1] op_sel_hi:[1,1,1]
    v_pk_fma_f32 v[222:223], v[222:223], v[170:171], v[170:171] op_sel:[0,1,1] op_sel_hi:[1,1,1]
    v_pk_fma_f32 v[224:225], v[224:225], v[174:175], v[174:175] op_sel:[0,1,1] op_sel_hi:[1,1,1]
    v_pk_fma_f32 v[226:227], v[226:227], v[174:175], v[174:175] op_sel:[0,1,1] op_sel_hi:[1,1,1]
    v_rcp_f32 v220, v220
    v_rcp_f32 v221, v221
    v_pk_mul_f32 v[140:141], v[140:141], v[56:57]
    v_rcp_f32 v222, v222
    v_rcp_f32 v223, v223
    v_pk_mul_f32 v[142:143], v[142:143], v[58:59]
    v_rcp_f32 v224, v224
    v_rcp_f32 v225, v225
    v_pk_mul_f32 v[144:145], v[144:145], v[60:61]
    v_rcp_f32 v226, v226
    v_rcp_f32 v227, v227
    v_pk_mul_f32 v[146:147], v[146:147], v[62:63]
    v_pk_mul_f32 v[140:141], v[140:141], v[220:221]
    v_pk_mul_f32 v[142:143], v[142:143], v[222:223]
    v_pk_mul_f32 v[144:145], v[144:145], v[224:225]
    v_pk_mul_f32 v[146:147], v[146:147], v[226:227]
    v_cvt_pk_bf16_f32 v84, v140, v141
    v_cvt_pk_bf16_f32 v85, v142, v143
    v_cvt_pk_bf16_f32 v86, v144, v145
    v_cvt_pk_bf16_f32 v87, v146, v147
    v_add_u32 v112, v244, v252
    v_permlane16_swap_b32 v84, v86
    v_permlane16_swap_b32 v85, v87
    s_waitcnt vmcnt(0)
    s_atomic_add s13, s[10:11], s12
    s_atomic_add s15, s[10:11], s14
    s_cmp_lt_u32 s63, 2
    s_cbranch_scc1 cg_s1
    s_atomic_add s17, s[10:11], s16
    s_cmp_lt_u32 s63, 3
    s_cbranch_scc1 cg_s1
    s_atomic_add s19, s[10:11], s18
cg_s1:
    v_mov_b32 v240, 160256
    v_mov_b32 v241, 1
    s_mov_b64 exec, 1
    ds_add_u32 v240, v241
    s_mov_b64 exec, -1
    buffer_store_dwordx4 v[84:87], v112, s[36:39], 0 offen sc1
    v_pk_fma_f32 v[64:65], v[204:205], v[176:177], v[64:65] op_sel:[0,0,0] op_sel_hi:[1,0,1]
    v_pk_fma_f32 v[66:67], v[206:207], v[176:177], v[66:67] op_sel:[0,0,0] op_sel_hi:[1,0,1]
    v_pk_fma_f32 v[68:69], v[204:205], v[180:181], v[68:69] op_sel:[0,0,0] op_sel_hi:[1,0,1]
    v_pk_fma_f32 v[70:71], v[206:207], v[180:181], v[70:71] op_sel:[0,0,0] op_sel_hi:[1,0,1]
    v_pk_mul_f32 v[220:221], v[64:65], v[64:65]
    v_pk_mul_f32 v[222:223], v[66:67], v[66:67]
    v_pk_mul_f32 v[224:225], v[68:69], v[68:69]
    v_pk_mul_f32 v[226:227], v[70:71], v[70:71]
    v_pk_fma_f32 v[220:221], v[220:221], v[178:179], v[176:177] op_sel:[0,0,1] op_sel_hi:[1,0,1]
    v_pk_fma_f32 v[222:223], v[222:223], v[178:179], v[176:177] op_sel:[0,0,1] op_sel_hi:[1,0,1]
    v_pk_fma_f32 v[224:225], v[224:225], v[182:183], v[180:181] op_sel:[0,0,1] op_sel_hi:[1,0,1]
    v_pk_fma_f32 v[226:227], v[226:227], v[182:183], v[180:181] op_sel:[0,0,1] op_sel_hi:[1,0,1]
    v_pk_mul_f32 v[220:221], v[220:221], v[64:65]
    v_pk_mul_f32 v[222:223], v[222:223], v[66:67]
    v_pk_mul_f32 v[224:225], v[224:225], v[68:69]
    v_pk_mul_f32 v[226:227], v[226:227], v[70:71]
    v_exp_f32 v220, v220
    v_exp_f32 v221, v221
    v_pk_fma_f32 v[148:149], v[216:217], v[176:177], v[148:149] op_sel:[0,0,0] op_sel_hi:[1,0,1]
    v_exp_f32 v222, v222
    v_exp_f32 v223, v223
    v_pk_fma_f32 v[150:151], v[218:219], v[176:177], v[150:151] op_sel:[0,0,0] op_sel_hi:[1,0,1]
    v_exp_f32 v224, v224
    v_exp_f32 v225, v225
    v_pk_fma_f32 v[152:153], v[216:217], v[180:181], v[152:153] op_sel:[0,0,0] op_sel_hi:[1,0,1]
    v_exp_f32 v226, v226
    v_exp_f32 v227, v227
    v_pk_fma_f32 v[154:155], v[218:219], v[180:181], v[154:155] op_sel:[0,0,0] op_sel_hi:[1,0,1]
    v_pk_fma_f32 v[220:221], v[220:221], v[178:179], v[178:179] op_sel:[0,1,1] op_sel_hi:[1,1,1]
    v_pk_fma_f32 v[222:223], v[222:223], v[178:179], v[178:179] op_sel:[0,1,1] op_sel_hi:[1,1,1]
    v_pk_fma_f32 v[224:225], v[224:225], v[182:183], v[182:183] op_sel:[0,1,1] op_sel_hi:[1,1,1]
    v_pk_fma_f32 v[226:227], v[226:227], v[182:183], v[182:183] op_sel:[0,1,1] op_sel_hi:[1,1,1]
    v_rcp_f32 v220, v220
    v_rcp_f32 v221, v221
    v_pk_mul_f32 v[148:149], v[148:149], v[64:65]
    v_rcp_f32 v222, v222
    v_rcp_f32 v223, v223
    v_pk_mul_f32 v[150:151], v[150:151], v[66:67]
    v_rcp_f32 v224, v224
    v_rcp_f32 v225, v225
    v_pk_mul_f32 v[152:153], v[152:153], v[68:69]
    v_rcp_f32 v226, v226
    v_rcp_f32 v227, v227
    v_pk_mul_f32 v[154:155], v[154:155], v[70:71]
    v_pk_mul_f32 v[148:149], v[148:149], v[220:221]
    v_pk_mul_f32 v[150:151], v[150:151], v[222:223]
    v_pk_mul_f32 v[152:153], v[152:153], v[224:225]
    v_pk_mul_f32 v[154:155], v[154:155], v[226:227]
    v_cvt_pk_bf16_f32 v92, v148, v149
    v_cvt_pk_bf16_f32 v93, v150, v151
    v_cvt_pk_bf16_f32 v94, v152, v153
    v_cvt_pk_bf16_f32 v95, v154, v155
    v_add_u32 v120, v245, v252
    v_permlane16_swap_b32 v92, v94
    v_permlane16_swap_b32 v93, v95
    buffer_store_dwordx4 v[92:95], v120, s[36:39], 0 offen sc1
    v_pk_fma_f32 v[72:73], v[204:205], v[184:185], v[72:73] op_sel:[0,0,0] op_sel_hi:[1,0,1]
    v_pk_fma_f32 v[74:75], v[206:207], v[184:185], v[74:75] op_sel:[0,0,0] op_sel_hi:[1,0,1]
    v_pk_fma_f32 v[76:77], v[204:205], v[188:189], v[76:77] op_sel:[0,0,0] op_sel_hi:[1,0,1]
    v_pk_fma_f32 v[78:79], v[206:207], v[188:189], v[78:79] op_sel:[0,0,0] op_sel_hi:[1,0,1]
    v_pk_mul_f32 v[220:221], v[72:73], v[72:73]
    v_pk_mul_f32 v[222:223], v[74:75], v[74:75]
    v_pk_mul_f32 v[224:225], v[76:77], v[76:77]
    v_pk_mul_f32 v[226:227], v[78:79], v[78:79]
    v_pk_fma_f32 v[220:221], v[220:221], v[186:187], v[184:185] op_sel:[0,0,1] op_sel_hi:[1,0,1]
    v_pk_fma_f32 v[222:223], v[222:223], v[186:187], v[184:185] op_sel:[0,0,1] op_sel_hi:[1,0,1]
    v_pk_fma_f32 v[224:225], v[224:225], v[190:191], v[188:189] op_sel:[0,0,1] op_sel_hi:[1,0,1]
    v_pk_fma_f32 v[226:227], v[226:227], v[190:191], v[188:189] op_sel:[0,0,1] op_sel_hi:[1,0,1]
    v_pk_mul_f32 v[220:221], v[220:221], v[72:73]
    v_pk_mul_f32 v[222:223], v[222:223], v[74:75]
    v_pk_mul_f32 v[224:225], v[224:225], v[76:77]
    v_pk_mul_f32 v[226:227], v[226:227], v[78:79]
    v_exp_f32 v220, v220
    v_exp_f32 v221, v221
    v_pk_fma_f32 v[156:157], v[216:217], v[184:185], v[156:157] op_sel:[0,0,0] op_sel_hi:[1,0,1]
    v_exp_f32 v222, v222
    v_exp_f32 v223, v223
    v_pk_fma_f32 v[158:159], v[218:219], v[184:185], v[158:159] op_sel:[0,0,0] op_sel_hi:[1,0,1]
    v_exp_f32 v224, v224
    v_exp_f32 v225, v225
    v_pk_fma_f32 v[160:161], v[216:217], v[188:189], v[160:161] op_sel:[0,0,0] op_sel_hi:[1,0,1]
    v_exp_f32 v226, v226
    v_exp_f32 v227, v227
    v_pk_fma_f32 v[162:163], v[218:219], v[188:189], v[162:163] op_sel:[0,0,0] op_sel_hi:[1,0,1]
    v_pk_fma_f32 v[220:221], v[220:221], v[186:187], v[186:187] op_sel:[0,1,1] op_sel_hi:[1,1,1]
    v_pk_fma_f32 v[222:223], v[222:223], v[186:187], v[186:187] op_sel:[0,1,1] op_sel_hi:[1,1,1]
    v_pk_fma_f32 v[224:225], v[224:225], v[190:191], v[190:191] op_sel:[0,1,1] op_sel_hi:[1,1,1]
    v_pk_fma_f32 v[226:227], v[226:227], v[190:191], v[190:191] op_sel:[0,1,1] op_sel_hi:[1,1,1]
    v_rcp_f32 v220, v220
    v_rcp_f32 v221, v221
    v_pk_mul_f32 v[156:157], v[156:157], v[72:73]
    v_rcp_f32 v222, v222
    v_rcp_f32 v223, v223
    v_pk_mul_f32 v[158:159], v[158:159], v[74:75]
    v_rcp_f32 v224, v224
    v_rcp_f32 v225, v225
    v_pk_mul_f32 v[160:161], v[160:161], v[76:77]
    v_rcp_f32 v226, v226
    v_rcp_f32 v227, v227
    v_pk_mul_f32 v[162:163], v[162:163], v[78:79]
    v_pk_mul_f32 v[156:157], v[156:157], v[220:221]
    v_pk_mul_f32 v[158:159], v[158:159], v[222:223]
    v_pk_mul_f32 v[160:161], v[160:161], v[224:225]
    v_pk_mul_f32 v[162:163], v[162:163], v[226:227]
    v_cvt_pk_bf16_f32 v100, v156, v157
    v_cvt_pk_bf16_f32 v101, v158, v159
    v_cvt_pk_bf16_f32 v102, v160, v161
    v_cvt_pk_bf16_f32 v103, v162, v163
    v_add_u32 v128, v246, v252
    v_permlane16_swap_b32 v100, v102
    v_permlane16_swap_b32 v101, v103
    buffer_store_dwordx4 v[100:103], v128, s[36:39], 0 offen sc1
    v_pk_fma_f32 v[80:81], v[204:205], v[192:193], v[80:81] op_sel:[0,0,0] op_sel_hi:[1,0,1]
    v_pk_fma_f32 v[82:83], v[206:207], v[192:193], v[82:83] op_sel:[0,0,0] op_sel_hi:[1,0,1]
    v_pk_mul_f32 v[220:221], v[80:81], v[80:81]
    v_pk_mul_f32 v[222:223], v[82:83], v[82:83]
    v_pk_fma_f32 v[220:221], v[220:221], v[194:195], v[192:193] op_sel:[0,0,1] op_sel_hi:[1,0,1]
    v_pk_fma_f32 v[222:223], v[222:223], v[194:195], v[192:193] op_sel:[0,0,1] op_sel_hi:[1,0,1]
    v_pk_mul_f32 v[220:221], v[220:221], v[80:81]
    v_pk_mul_f32 v[222:223], v[222:223], v[82:83]
    v_exp_f32 v220, v220
    v_exp_f32 v221, v221
    v_pk_fma_f32 v[164:165], v[216:217], v[192:193], v[164:165] op_sel:[0,0,0] op_sel_hi:[1,0,1]
    v_exp_f32 v222, v222
    v_exp_f32 v223, v223
    v_pk_fma_f32 v[166:167], v[218:219], v[192:193], v[166:167] op_sel:[0,0,0] op_sel_hi:[1,0,1]
    v_pk_fma_f32 v[220:221], v[220:221], v[194:195], v[194:195] op_sel:[0,1,1] op_sel_hi:[1,1,1]
    v_pk_fma_f32 v[222:223], v[222:223], v[194:195], v[194:195] op_sel:[0,1,1] op_sel_hi:[1,1,1]
    v_rcp_f32 v220, v220
    v_rcp_f32 v221, v221
    v_pk_mul_f32 v[164:165], v[164:165], v[80:81]
    v_rcp_f32 v222, v222
    v_rcp_f32 v223, v223
    v_pk_mul_f32 v[166:167], v[166:167], v[82:83]
    v_pk_mul_f32 v[164:165], v[164:165], v[220:221]
    v_pk_mul_f32 v[166:167], v[166:167], v[222:223]
    v_cvt_pk_bf16_f32 v108, v164, v165
    v_cvt_pk_bf16_f32 v109, v166, v167
    v_add_u32 v136, v247, v252
    v_permlane16_swap_b32 v108, v110
    v_permlane16_swap_b32 v109, v111
    buffer_store_dwordx4 v[108:111], v136, s[36:39], 0 offen sc1
    s_waitcnt lgkmcnt(0)
    s_lshl_b32 s13, s13, 16
    s_lshl_b32 s15, s15, 16
    s_lshl_b32 s17, s17, 16
    s_lshl_b32 s19, s19, 16
    s_branch k_pub2
k_consq:
    s_mov_b64 s[24:25], 0
    s_mov_b64 s[26:27], 0
    s_mov_b64 s[28:29], 0
    s_mov_b64 s[30:31], 0
    s_mov_b64 s[32:33], 0
    s_mov_b64 s[34:35], 0
    s_mov_b32 s56, 1
    v_mov_b32 v176, 0
    v_mov_b32 v177, 0
    v_mov_b32 v178, 0
    v_mov_b32 v179, 0
    v_lshrrev_b32 v184, 4, v243
    v_and_b32 v185, 15, v243
    v_bfe_u32 v186, v243, 2, 2
    v_and_b32 v187, 3, v243
    v_mfma_f32_32x32x16_bf16 v[0:15], v[176:179], v[176:179], 0
    v_mfma_f32_32x32x16_bf16 v[16:31], v[176:179], v[176:179], 0
    v_mfma_f32_32x32x16_bf16 v[32:47], v[176:179], v[176:179], 0
    v_mfma_f32_32x32x16_bf16 v[48:63], v[176:179], v[176:179], 0
    v_mfma_f32_32x32x16_bf16 v[64:79], v[176:179], v[176:179], 0
    v_mfma_f32_32x32x16_bf16 v[80:95], v[176:179], v[176:179], 0
    v_mfma_f32_32x32x16_bf16 v[96:111], v[176:179], v[176:179], 0
    v_mfma_f32_32x32x16_bf16 v[112:127], v[176:179], v[176:179], 0
    v_mfma_f32_32x32x16_bf16 v[128:143], v[176:179], v[176:179], 0
    v_mfma_f32_32x32x16_bf16 v[144:159], v[176:179], v[176:179], 0
    v_mfma_f32_32x32x16_bf16 v[160:175], v[176:179], v[176:179], 0
    v_lshrrev_b32 v188, 1, v185
    v_xor_b32 v188, v188, v184
    v_lshlrev_b32 v188, 4, v188
    v_lshl_or_b32 v188, v185, 7, v188
    v_add_u32 v240, 61440, v188
    v_xor_b32 v241, 64, v240
    v_mov_b32 v238, v240
    v_mov_b32 v239, v241
    v_mov_b32 v242, 0x3f803f80
    v_cmp_eq_u32 s[64:65], 0, v185
    v_mov_b32 v188, 160256
    ds_write_b128 v188, v[176:179]
    v_lshlrev_b32 v248, 4, v185
    v_add_u32 v248, 156672, v248
    s_mov_b64 s[24:25], -1
    s_mov_b32 s26, 0xffff0000
    s_mov_b32 s27, -1
    s_mov_b32 s28, 0xffff
    s_mov_b32 s30, 0xffff0000
    s_mov_b32 s33, 0xffff
    s_mov_b32 s35, 0xffff0000
    v_lshrrev_b32 v188, 1, v184
    v_lshlrev_b32 v188, 4, v188
    v_and_b32 v189, 1, v184
    v_lshl_add_u32 v188, v189, 2, v188
    v_add_u32 v188, v188, v186
    v_mul_u32_u24 v188, 160, v188
    s_mul_i32 s51, s40, 40
    v_add_u32 v188, s51, v188
    v_lshl_add_u32 v224, v187, 3, v188
    v_min_u32 v189, 2, v187
    v_mul_u32_u24 v189, 5120, v189
    v_add3_u32 v225, v188, v189, 32
    s_mul_i32 s51, s40, 1408
    s_add_u32 s51, s51, 143360
    v_lshl_add_u32 v228, v185, 3, s51
    v_add_u32 v188, 5632, v228
    v_cmp_eq_u32 vcc, 2, v184
    s_nop 1
    v_cndmask_b32 v228, v188, v228, vcc
    v_lshrrev_b32 v188, 2, v243
    v_lshl_add_u32 v229, v188, 3, s51
    v_lshlrev_b32 v230, 4, v184
    v_add_u32 v230, 160320, v230
    v_and_b32 v188, 1, v185
    v_cmp_eq_u32 s[74:75], 1, v188
    v_lshl_add_u32 v189, v184, 2, v188
    v_cmp_le_u32 s[76:77], v189, v185
    v_add_u32 v189, 2, v189
    v_cmp_le_u32 s[78:79], v189, v185
    v_mov_b32 v190, 0x0c0c0c0c
    v_mov_b32 v188, 0x0c0c0100
    v_mov_b32 v189, 0x01000c0c
    v_cndmask_b32 v188, v188, v189, s[74:75]
    v_cndmask_b32 v232, v188, v190, s[76:77]
    v_cndmask_b32 v234, v190, v188, s[76:77]
    v_mov_b32 v188, 0x0c0c0302
    v_mov_b32 v189, 0x03020c0c
    v_cndmask_b32 v188, v188, v189, s[74:75]
    v_cndmask_b32 v233, v188, v190, s[78:79]
    v_cndmask_b32 v235, v190, v188, s[78:79]
    s_mul_i32 s56, s45, 10
    s_lshr_b32 s57, s44, 1
    s_mul_i32 s57, s57, 17
    s_add_u32 s57, s57, 12
    s_and_b32 s58, s44, 1
    s_lshl_b32 s58, s58, 1
    s_lshr_b32 s52, s40, 1
    s_add_u32 s58, s58, s52
    s_and_b32 s53, s40, 1
    s_add_u32 s59, s57, s58
    s_lshl_b32 s59, s59, 12
    s_lshl_b32 s52, s53, 7
    s_add_u32 s59, s59, s52
    s_lshl_b32 s52, s53, 9
    v_lshrrev_b32 v188, 1, v184
    v_lshlrev_b32 v188, 6, v188
    v_and_b32 v189, 1, v184
    v_lshl_add_u32 v188, v189, 10, v188
    v_lshl_add_u32 v188, v186, 8, v188
    v_lshl_add_u32 v188, v187, 4, v188
    v_add_u32 v236, s59, v188
    s_add_u32 s57, s57, 4
    s_lshl_b32 s57, s57, 12
    s_add_u32 s57, s57, s52
    s_lshl_b32 s58, s58, 7
    s_add_u32 s57, s57, s58
    v_add_u32 v188, s56, v184
    v_lshrrev_b32 v189, 2, v188
    s_mov_b32 s58, 278528
    v_mul_lo_u32 v189, v189, s58
    v_and_b32 v188, 3, v188
    v_lshl_add_u32 v189, v188, 10, v189
    v_lshl_add_u32 v189, v185, 3, v189
    v_add_u32 v237, s57, v189
    v_mov_b32 v188, 2130706432
    v_cmp_gt_u32 vcc, 2, v184
    s_nop 1
    v_cndmask_b32 v244, v188, v237, vcc
    s_add_u32 s57, s56, 0
    s_lshr_b32 s59, s57, 2
    s_mul_i32 s59, s59, s58
    s_and_b32 s57, s57, 3
    s_lshl_b32 s57, s57, 10
    s_add_u32 s48, s59, s57
    s_add_u32 s57, s56, 2
    s_lshr_b32 s59, s57, 2
    s_mul_i32 s59, s59, s58
    s_and_b32 s57, s57, 3
    s_lshl_b32 s57, s57, 10
    s_add_u32 s49, s59, s57
    s_add_u32 s57, s56, 4
    s_lshr_b32 s59, s57, 2
    s_mul_i32 s59, s59, s58
    s_and_b32 s57, s57, 3
    s_lshl_b32 s57, s57, 10
    s_add_u32 s50, s59, s57
    s_add_u32 s57, s56, 6
    s_lshr_b32 s59, s57, 2
    s_mul_i32 s59, s59, s58
    s_and_b32 s57, s57, 3
    s_lshl_b32 s57, s57, 10
    s_add_u32 s51, s59, s57
    s_add_u32 s57, s56, 8
    s_lshr_b32 s59, s57, 2
    s_mul_i32 s59, s59, s58
    s_and_b32 s57, s57, 3
    s_lshl_b32 s57, s57, 10
    s_add_u32 s52, s59, s57
    s_lshl_b32 s53, s58, 1
    s_waitcnt lgkmcnt(0)
    s_add_u32 s62, s41, 16
    s_add_u32 s63, s41, 175
    s_movk_i32 s66, 410
    s_movk_i32 s67, 128
    s_lshr_b32 s62, s62, 6
    s_min_u32 s63, s63, 2047
    s_lshr_b32 s63, s63, 6
    s_lshr_b32 s20, s44, 1
    s_add_u32 s20, s20, 32
    s_and_b32 s21, s44, 1
    s_lshl_b32 s21, s21, 2
    s_add_u32 s12, s62, 0
    s_lshl_b32 s13, s12, 6
    s_mul_i32 s13, s13, s66
    s_lshr_b32 s13, s13, 16
    s_sub_u32 s13, s45, s13
    s_lshl_b32 s13, s13, 3
    s_add_u32 s13, s13, s21
    s_lshl_b32 s13, 1, s13
    s_lshl_b32 s12, s12, 2
    s_add_u32 s12, s12, s20
    s_mul_i32 s12, s12, 256
    s_add_u32 s12, s12, s67
    s_add_u32 s14, s62, 1
    s_lshl_b32 s15, s14, 6
    s_mul_i32 s15, s15, s66
    s_lshr_b32 s15, s15, 16
    s_sub_u32 s15, s45, s15
    s_lshl_b32 s15, s15, 3
    s_add_u32 s15, s15, s21
    s_lshl_b32 s15, 1, s15
    s_lshl_b32 s14, s14, 2
    s_add_u32 s14, s14, s20
    s_mul_i32 s14, s14, 256
    s_add_u32 s14, s14, s67
    s_add_u32 s16, s62, 2
    s_lshl_b32 s17, s16, 6
    s_mul_i32 s17, s17, s66
    s_lshr_b32 s17, s17, 16
    s_sub_u32 s17, s45, s17
    s_lshl_b32 s17, s17, 3
    s_add_u32 s17, s17, s21
    s_lshl_b32 s17, 1, s17
    s_lshl_b32 s16, s16, 2
    s_add_u32 s16, s16, s20
    s_mul_i32 s16, s16, 256
    s_add_u32 s16, s16, s67
    s_add_u32 s18, s62, 3
    s_lshl_b32 s19, s18, 6
    s_mul_i32 s19, s19, s66
    s_lshr_b32 s19, s19, 16
    s_sub_u32 s19, s45, s19
    s_lshl_b32 s19, s19, 3
    s_add_u32 s19, s19, s21
    s_lshl_b32 s19, 1, s19
    s_lshl_b32 s18, s18, 2
    s_add_u32 s18, s18, s20
    s_mul_i32 s18, s18, 256
    s_add_u32 s18, s18, s67
    s_sub_u32 s63, s63, s62
    s_add_u32 s10, s22, 21037056
    s_addc_u32 s11, s23, 0
    s_mov_b32 s36, s22
    s_mov_b32 s37, s23
    s_mov_b32 s38, 8912896
    s_mov_b32 s39, 0x20000
    s_mov_b32 s60, 0
    s_mov_b32 s61, 0
    s_barrier
    ds_read_b64_tr_b16 v[176:177], v224 offset:0
    ds_read_b64_tr_b16 v[178:179], v224 offset:1280
    ds_read_b64_tr_b16 v[180:181], v224 offset:5120
    ds_read_b64_tr_b16 v[182:183], v224 offset:6400
    ds_read_b64_tr_b16 v[184:185], v224 offset:10240
    ds_read_b64_tr_b16 v[186:187], v224 offset:11520
    ds_read_b64_tr_b16 v[188:189], v225 offset:0
    ds_read_b64_tr_b16 v[190:191], v225 offset:1280
    ds_read_b128 v[208:211], v238 offset:0
    ds_read_b128 v[212:215], v238 offset:2048
    ds_read_b128 v[216:219], v238 offset:4096
    s_waitcnt lgkmcnt(2)
    v_cndmask_b32 v208, v208, v242, s[64:65]
    v_cndmask_b32 v209, v209, v242, s[64:65]
    v_cndmask_b32 v210, v210, v242, s[64:65]
    v_cndmask_b32 v211, v211, v242, s[64:65]
cq_loop:
    s_nop 1
    v_mfma_f32_16x16x32_bf16 v[0:3], v[176:179], v[208:211], v[0:3]
    ds_read_b128 v[220:223], v238 offset:6144
    v_mfma_f32_16x16x32_bf16 v[44:47], v[180:183], v[208:211], v[44:47]
    s_barrier
    v_mfma_f32_16x16x32_bf16 v[88:91], v[208:211], v[184:187], v[88:91]
    ds_read_b64_tr_b16 v[192:193], v224 offset:15360
    v_mfma_f32_16x16x32_bf16 v[132:135], v[188:191], v[208:211], v[132:135]
    s_waitcnt lgkmcnt(3)
    v_mfma_f32_16x16x32_bf16 v[4:7], v[176:179], v[212:215], v[4:7]
    ds_read_b128 v[208:211], v238 offset:8192
    v_mfma_f32_16x16x32_bf16 v[48:51], v[180:183], v[212:215], v[48:51]
    ds_read_b64_tr_b16 v[194:195], v224 offset:16640
    v_mfma_f32_16x16x32_bf16 v[92:95], v[212:215], v[184:187], v[92:95]
    ds_read_b64_tr_b16 v[196:197], v224 offset:20480
    v_mfma_f32_16x16x32_bf16 v[136:139], v[188:191], v[212:215], v[136:139]
    s_waitcnt lgkmcnt(5)
    v_mfma_f32_16x16x32_bf16 v[8:11], v[176:179], v[216:219], v[8:11]
    ds_read_b128 v[212:215], v238 offset:10240
    v_mfma_f32_16x16x32_bf16 v[52:55], v[180:183], v[216:219], v[52:55]
    ds_read_b64_tr_b16 v[198:199], v224 offset:21760
    v_mfma_f32_16x16x32_bf16 v[96:99], v[216:219], v[184:187], v[96:99]
    ds_read_b64_tr_b16 v[200:201], v224 offset:25600
    v_mfma_f32_16x16x32_bf16 v[140:143], v[188:191], v[216:219], v[140:143]
    s_waitcnt lgkmcnt(7)
    v_mfma_f32_16x16x32_bf16 v[12:15], v[176:179], v[220:223], v[12:15]
    ds_read_b128 v[216:219], v238 offset:12288
    v_mfma_f32_16x16x32_bf16 v[56:59], v[180:183], v[220:223], v[56:59]
    ds_read_b64_tr_b16 v[202:203], v224 offset:26880
    v_mfma_f32_16x16x32_bf16 v[100:103], v[220:223], v[184:187], v[100:103]
    v_mfma_f32_16x16x32_bf16 v[144:147], v[188:191], v[220:223], v[144:147]
    s_waitcnt lgkmcnt(7)
    v_mfma_f32_16x16x32_bf16 v[16:19], v[176:179], v[208:211], v[16:19]
    ds_read_b128 v[220:223], v238 offset:14336
    v_mfma_f32_16x16x32_bf16 v[60:63], v[180:183], v[208:211], v[60:63]
    ds_read_b64_tr_b16 v[204:205], v225 offset:15360
    v_mfma_f32_16x16x32_bf16 v[104:107], v[208:211], v[184:187], v[104:107]
    v_mfma_f32_16x16x32_bf16 v[148:151], v[188:191], v[208:211], v[148:151]
    s_waitcnt lgkmcnt(6)
    v_mfma_f32_16x16x32_bf16 v[20:23], v[176:179], v[212:215], v[20:23]
    ds_read_b128 v[208:211], v238 offset:16384
    v_mfma_f32_16x16x32_bf16 v[64:67], v[180:183], v[212:215], v[64:67]
    ds_read_b64_tr_b16 v[206:207], v225 offset:16640
    v_mfma_f32_16x16x32_bf16 v[108:111], v[212:215], v[184:187], v[108:111]
    v_mfma_f32_16x16x32_bf16 v[152:155], v[188:191], v[212:215], v[152:155]
    s_waitcnt lgkmcnt(5)
    v_mfma_f32_16x16x32_bf16 v[24:27], v[176:179], v[216:219], v[24:27]
    ds_read_b128 v[212:215], v238 offset:18432
    v_mfma_f32_16x16x32_bf16 v[68:71], v[180:183], v[216:219], v[68:71]
    v_mfma_f32_16x16x32_bf16 v[112:115], v[216:219], v[184:187], v[112:115]
    v_mfma_f32_16x16x32_bf16 v[156:159], v[188:191], v[216:219], v[156:159]
    s_waitcnt lgkmcnt(4)
    v_mfma_f32_16x16x32_bf16 v[28:31], v[176:179], v[220:223], v[28:31]
    ds_read_b128 v[216:219], v238 offset:20480
    v_mfma_f32_16x16x32_bf16 v[72:75], v[180:183], v[220:223], v[72:75]
    v_mfma_f32_16x16x32_bf16 v[116:119], v[220:223], v[184:187], v[116:119]
    v_mfma_f32_16x16x32_bf16 v[160:163], v[188:191], v[220:223], v[160:163]
    s_waitcnt lgkmcnt(3)
    v_mfma_f32_16x16x32_bf16 v[32:35], v[176:179], v[208:211], v[32:35]
    ds_read_b128 v[220:223], v239 offset:0
    v_mfma_f32_16x16x32_bf16 v[76:79], v[180:183], v[208:211], v[76:79]
    s_add_u32 s60, s60, 22528
    s_cmp_ge_u32 s60, 67584
    v_mfma_f32_16x16x32_bf16 v[120:123], v[208:211], v[184:187], v[120:123]
    s_cselect_b32 s60, 0, s60
    v_add_u32 v238, s60, v240
    v_mfma_f32_16x16x32_bf16 v[164:167], v[188:191], v[208:211], v[164:167]
    s_waitcnt lgkmcnt(2)
    v_mfma_f32_16x16x32_bf16 v[36:39], v[176:179], v[212:215], v[36:39]
    ds_read_b128 v[208:211], v239 offset:2048
    v_mfma_f32_16x16x32_bf16 v[80:83], v[180:183], v[212:215], v[80:83]
    v_mfma_f32_16x16x32_bf16 v[124:127], v[212:215], v[184:187], v[124:127]
    v_mfma_f32_16x16x32_bf16 v[168:171], v[188:191], v[212:215], v[168:171]
    s_waitcnt lgkmcnt(2)
    v_mfma_f32_16x16x32_bf16 v[40:43], v[176:179], v[216:219], v[40:43]
    ds_read_b128 v[212:215], v239 offset:4096
    v_mfma_f32_16x16x32_bf16 v[84:87], v[180:183], v[216:219], v[84:87]
    s_waitcnt lgkmcnt(2)
    v_cndmask_b32 v220, v220, v242, s[64:65]
    v_cndmask_b32 v221, v221, v242, s[64:65]
    v_mfma_f32_16x16x32_bf16 v[128:131], v[216:219], v[184:187], v[128:131]
    v_cndmask_b32 v222, v222, v242, s[64:65]
    v_cndmask_b32 v223, v223, v242, s[64:65]
    v_mfma_f32_16x16x32_bf16 v[172:175], v[188:191], v[216:219], v[172:175]
    s_nop 0
    v_mfma_f32_16x16x32_bf16 v[0:3], v[192:195], v[220:223], v[0:3]
    ds_read_b128 v[216:219], v239 offset:6144
    v_mfma_f32_16x16x32_bf16 v[44:47], v[196:199], v[220:223], v[44:47]
    s_barrier
    v_mfma_f32_16x16x32_bf16 v[88:91], v[220:223], v[200:203], v[88:91]
    ds_read_b64_tr_b16 v[176:177], v224 offset:30720
    v_mfma_f32_16x16x32_bf16 v[132:135], v[204:207], v[220:223], v[132:135]
    s_waitcnt lgkmcnt(3)
    v_mfma_f32_16x16x32_bf16 v[4:7], v[192:195], v[208:211], v[4:7]
    ds_read_b128 v[220:223], v239 offset:8192
    v_mfma_f32_16x16x32_bf16 v[48:51], v[196:199], v[208:211], v[48:51]
    ds_read_b64_tr_b16 v[178:179], v224 offset:32000
    v_mfma_f32_16x16x32_bf16 v[92:95], v[208:211], v[200:203], v[92:95]
    ds_read_b64_tr_b16 v[180:181], v224 offset:35840
    v_mfma_f32_16x16x32_bf16 v[136:139], v[204:207], v[208:211], v[136:139]
    s_waitcnt lgkmcnt(5)
    v_mfma_f32_16x16x32_bf16 v[8:11], v[192:195], v[212:215], v[8:11]
    ds_read_b128 v[208:211], v239 offset:10240
    v_mfma_f32_16x16x32_bf16 v[52:55], v[196:199], v[212:215], v[52:55]
    ds_read_b64_tr_b16 v[182:183], v224 offset:37120
    v_mfma_f32_16x16x32_bf16 v[96:99], v[212:215], v[200:203], v[96:99]
    ds_read_b64_tr_b16 v[184:185], v224 offset:40960
    v_mfma_f32_16x16x32_bf16 v[140:143], v[204:207], v[212:215], v[140:143]
    s_waitcnt lgkmcnt(7)
    v_mfma_f32_16x16x32_bf16 v[12:15], v[192:195], v[216:219], v[12:15]
    ds_read_b128 v[212:215], v239 offset:12288
    v_mfma_f32_16x16x32_bf16 v[56:59], v[196:199], v[216:219], v[56:59]
    ds_read_b64_tr_b16 v[186:187], v224 offset:42240
    v_mfma_f32_16x16x32_bf16 v[100:103], v[216:219], v[200:203], v[100:103]
    v_mfma_f32_16x16x32_bf16 v[144:147], v[204:207], v[216:219], v[144:147]
    s_waitcnt lgkmcnt(7)
    v_mfma_f32_16x16x32_bf16 v[16:19], v[192:195], v[220:223], v[16:19]
    ds_read_b128 v[216:219], v239 offset:14336
    v_mfma_f32_16x16x32_bf16 v[60:63], v[196:199], v[220:223], v[60:63]
    ds_read_b64_tr_b16 v[188:189], v225 offset:30720
    v_mfma_f32_16x16x32_bf16 v[104:107], v[220:223], v[200:203], v[104:107]
    v_mfma_f32_16x16x32_bf16 v[148:151], v[204:207], v[220:223], v[148:151]
    s_waitcnt lgkmcnt(6)
    v_mfma_f32_16x16x32_bf16 v[20:23], v[192:195], v[208:211], v[20:23]
    ds_read_b128 v[220:223], v239 offset:16384
    v_mfma_f32_16x16x32_bf16 v[64:67], v[196:199], v[208:211], v[64:67]
    ds_read_b64_tr_b16 v[190:191], v225 offset:32000
    v_mfma_f32_16x16x32_bf16 v[108:111], v[208:211], v[200:203], v[108:111]
    v_mfma_f32_16x16x32_bf16 v[152:155], v[204:207], v[208:211], v[152:155]
    s_waitcnt lgkmcnt(5)
    v_mfma_f32_16x16x32_bf16 v[24:27], v[192:195], v[212:215], v[24:27]
    ds_read_b128 v[208:211], v239 offset:18432
    v_mfma_f32_16x16x32_bf16 v[68:71], v[196:199], v[212:215], v[68:71]
    v_mfma_f32_16x16x32_bf16 v[112:115], v[212:215], v[200:203], v[112:115]
    v_mfma_f32_16x16x32_bf16 v[156:159], v[204:207], v[212:215], v[156:159]
    s_waitcnt lgkmcnt(4)
    v_mfma_f32_16x16x32_bf16 v[28:31], v[192:195], v[216:219], v[28:31]
    ds_read_b128 v[212:215], v239 offset:20480
    v_mfma_f32_16x16x32_bf16 v[72:75], v[196:199], v[216:219], v[72:75]
    v_mfma_f32_16x16x32_bf16 v[116:119], v[216:219], v[200:203], v[116:119]
    v_mfma_f32_16x16x32_bf16 v[160:163], v[204:207], v[216:219], v[160:163]
    s_waitcnt lgkmcnt(3)
    v_mfma_f32_16x16x32_bf16 v[32:35], v[192:195], v[220:223], v[32:35]
    ds_read_b128 v[216:219], v238 offset:0
    v_mfma_f32_16x16x32_bf16 v[76:79], v[196:199], v[220:223], v[76:79]
    v_add_u32 v239, s60, v241
    v_mfma_f32_16x16x32_bf16 v[120:123], v[220:223], v[200:203], v[120:123]
    v_mfma_f32_16x16x32_bf16 v[164:167], v[204:207], v[220:223], v[164:167]
    s_waitcnt lgkmcnt(2)
    v_mfma_f32_16x16x32_bf16 v[36:39], v[192:195], v[208:211], v[36:39]
    ds_read_b128 v[220:223], v238 offset:2048
    v_mfma_f32_16x16x32_bf16 v[80:83], v[196:199], v[208:211], v[80:83]
    v_mfma_f32_16x16x32_bf16 v[124:127], v[208:211], v[200:203], v[124:127]
    v_mfma_f32_16x16x32_bf16 v[168:171], v[204:207], v[208:211], v[168:171]
    s_waitcnt lgkmcnt(2)
    v_mfma_f32_16x16x32_bf16 v[40:43], v[192:195], v[212:215], v[40:43]
    ds_read_b128 v[208:211], v238 offset:4096
    v_mfma_f32_16x16x32_bf16 v[84:87], v[196:199], v[212:215], v[84:87]
    s_waitcnt lgkmcnt(2)
    v_cndmask_b32 v216, v216, v242, s[64:65]
    v_cndmask_b32 v217, v217, v242, s[64:65]
    v_mfma_f32_16x16x32_bf16 v[128:131], v[212:215], v[200:203], v[128:131]
    v_cndmask_b32 v218, v218, v242, s[64:65]
    v_cndmask_b32 v219, v219, v242, s[64:65]
    v_mfma_f32_16x16x32_bf16 v[172:175], v[204:207], v[212:215], v[172:175]
    s_nop 0
    v_mfma_f32_16x16x32_bf16 v[0:3], v[176:179], v[216:219], v[0:3]
    ds_read_b128 v[212:215], v238 offset:6144
    v_mfma_f32_16x16x32_bf16 v[44:47], v[180:183], v[216:219], v[44:47]
    s_cmp_eq_u32 s61, 4
    s_cbranch_scc1 cq_nb2
    s_barrier
cq_nb2:
    v_mfma_f32_16x16x32_bf16 v[88:91], v[216:219], v[184:187], v[88:91]
    ds_read_b64_tr_b16 v[192:193], v224 offset:46080
    v_mfma_f32_16x16x32_bf16 v[132:135], v[188:191], v[216:219], v[132:135]
    s_waitcnt lgkmcnt(3)
    v_mfma_f32_16x16x32_bf16 v[4:7], v[176:179], v[220:223], v[4:7]
    ds_read_b128 v[216:219], v238 offset:8192
    v_mfma_f32_16x16x32_bf16 v[48:51], v[180:183], v[220:223], v[48:51]
    ds_read_b64_tr_b16 v[194:195], v224 offset:47360
    v_mfma_f32_16x16x32_bf16 v[92:95], v[220:223], v[184:187], v[92:95]
    ds_read_b64_tr_b16 v[196:197], v224 offset:51200
    v_mfma_f32_16x16x32_bf16 v[136:139], v[188:191], v[220:223], v[136:139]
    s_waitcnt lgkmcnt(5)
    v_mfma_f32_16x16x32_bf16 v[8:11], v[176:179], v[208:211], v[8:11]
    ds_read_b128 v[220:223], v238 offset:10240
    v_mfma_f32_16x16x32_bf16 v[52:55], v[180:183], v[208:211], v[52:55]
    ds_read_b64_tr_b16 v[198:199], v224 offset:52480
    v_mfma_f32_16x16x32_bf16 v[96:99], v[208:211], v[184:187], v[96:99]
    ds_read_b64_tr_b16 v[200:201], v224 offset:56320
    v_mfma_f32_16x16x32_bf16 v[140:143], v[188:191], v[208:211], v[140:143]
    s_waitcnt lgkmcnt(7)
    v_mfma_f32_16x16x32_bf16 v[12:15], v[176:179], v[212:215], v[12:15]
    ds_read_b128 v[208:211], v238 offset:12288
    v_mfma_f32_16x16x32_bf16 v[56:59], v[180:183], v[212:215], v[56:59]
    ds_read_b64_tr_b16 v[202:203], v224 offset:57600
    v_mfma_f32_16x16x32_bf16 v[100:103], v[212:215], v[184:187], v[100:103]
    v_mfma_f32_16x16x32_bf16 v[144:147], v[188:191], v[212:215], v[144:147]
    s_waitcnt lgkmcnt(7)
    v_mfma_f32_16x16x32_bf16 v[16:19], v[176:179], v[216:219], v[16:19]
    ds_read_b128 v[212:215], v238 offset:14336
    v_mfma_f32_16x16x32_bf16 v[60:63], v[180:183], v[216:219], v[60:63]
    ds_read_b64_tr_b16 v[204:205], v225 offset:46080
    v_mfma_f32_16x16x32_bf16 v[104:107], v[216:219], v[184:187], v[104:107]
    v_mfma_f32_16x16x32_bf16 v[148:151], v[188:191], v[216:219], v[148:151]
    s_waitcnt lgkmcnt(6)
    v_mfma_f32_16x16x32_bf16 v[20:23], v[176:179], v[220:223], v[20:23]
    ds_read_b128 v[216:219], v238 offset:16384
    v_mfma_f32_16x16x32_bf16 v[64:67], v[180:183], v[220:223], v[64:67]
    ds_read_b64_tr_b16 v[206:207], v225 offset:47360
    v_mfma_f32_16x16x32_bf16 v[108:111], v[220:223], v[184:187], v[108:111]
    v_mfma_f32_16x16x32_bf16 v[152:155], v[188:191], v[220:223], v[152:155]
    s_waitcnt lgkmcnt(5)
    v_mfma_f32_16x16x32_bf16 v[24:27], v[176:179], v[208:211], v[24:27]
    ds_read_b128 v[220:223], v238 offset:18432
    v_mfma_f32_16x16x32_bf16 v[68:71], v[180:183], v[208:211], v[68:71]
    v_mfma_f32_16x16x32_bf16 v[112:115], v[208:211], v[184:187], v[112:115]
    v_mfma_f32_16x16x32_bf16 v[156:159], v[188:191], v[208:211], v[156:159]
    s_waitcnt lgkmcnt(4)
    v_mfma_f32_16x16x32_bf16 v[28:31], v[176:179], v[212:215], v[28:31]
    ds_read_b128 v[208:211], v238 offset:20480
    v_mfma_f32_16x16x32_bf16 v[72:75], v[180:183], v[212:215], v[72:75]
    v_mfma_f32_16x16x32_bf16 v[116:119], v[212:215], v[184:187], v[116:119]
    v_mfma_f32_16x16x32_bf16 v[160:163], v[188:191], v[212:215], v[160:163]
    s_waitcnt lgkmcnt(3)
    v_mfma_f32_16x16x32_bf16 v[32:35], v[176:179], v[216:219], v[32:35]
    ds_read_b128 v[212:215], v239 offset:0
    v_mfma_f32_16x16x32_bf16 v[76:79], v[180:183], v[216:219], v[76:79]
    s_add_u32 s60, s60, 22528
    s_cmp_ge_u32 s60, 67584
    v_mfma_f32_16x16x32_bf16 v[120:123], v[216:219], v[184:187], v[120:123]
    s_cselect_b32 s60, 0, s60
    v_add_u32 v238, s60, v240
    v_mfma_f32_16x16x32_bf16 v[164:167], v[188:191], v[216:219], v[164:167]
    s_waitcnt lgkmcnt(2)
    v_mfma_f32_16x16x32_bf16 v[36:39], v[176:179], v[220:223], v[36:39]
    ds_read_b128 v[216:219], v239 offset:2048
    v_mfma_f32_16x16x32_bf16 v[80:83], v[180:183], v[220:223], v[80:83]
    v_mfma_f32_16x16x32_bf16 v[124:127], v[220:223], v[184:187], v[124:127]
    v_mfma_f32_16x16x32_bf16 v[168:171], v[188:191], v[220:223], v[168:171]
    s_waitcnt lgkmcnt(2)
    v_mfma_f32_16x16x32_bf16 v[40:43], v[176:179], v[208:211], v[40:43]
    ds_read_b128 v[220:223], v239 offset:4096
    v_mfma_f32_16x16x32_bf16 v[84:87], v[180:183], v[208:211], v[84:87]
    s_waitcnt lgkmcnt(2)
    v_cndmask_b32 v212, v212, v242, s[64:65]
    v_cndmask_b32 v213, v213, v242, s[64:65]
    v_mfma_f32_16x16x32_bf16 v[128:131], v[208:211], v[184:187], v[128:131]
    v_cndmask_b32 v214, v214, v242, s[64:65]
    v_cndmask_b32 v215, v215, v242, s[64:65]
    v_mfma_f32_16x16x32_bf16 v[172:175], v[188:191], v[208:211], v[172:175]
    s_nop 0
    v_mfma_f32_16x16x32_bf16 v[0:3], v[192:195], v[212:215], v[0:3]
    ds_read_b128 v[208:211], v239 offset:6144
    v_mfma_f32_16x16x32_bf16 v[44:47], v[196:199], v[212:215], v[44:47]
    s_cmp_eq_u32 s61, 4
    s_cbranch_scc1 cq_nb3
    s_barrier
cq_nb3:
    v_mfma_f32_16x16x32_bf16 v[88:91], v[212:215], v[200:203], v[88:91]
    ds_read_b64_tr_b16 v[176:177], v224 offset:0
    v_mfma_f32_16x16x32_bf16 v[132:135], v[204:207], v[212:215], v[132:135]
    s_waitcnt lgkmcnt(3)
    v_mfma_f32_16x16x32_bf16 v[4:7], v[192:195], v[216:219], v[4:7]
    ds_read_b128 v[212:215], v239 offset:8192
    v_mfma_f32_16x16x32_bf16 v[48:51], v[196:199], v[216:219], v[48:51]
    ds_read_b64_tr_b16 v[178:179], v224 offset:1280
    v_mfma_f32_16x16x32_bf16 v[92:95], v[216:219], v[200:203], v[92:95]
    ds_read_b64_tr_b16 v[180:181], v224 offset:5120
    v_mfma_f32_16x16x32_bf16 v[136:139], v[204:207], v[216:219], v[136:139]
    s_waitcnt lgkmcnt(5)
    v_mfma_f32_16x16x32_bf16 v[8:11], v[192:195], v[220:223], v[8:11]
    ds_read_b128 v[216:219], v239 offset:10240
    v_mfma_f32_16x16x32_bf16 v[52:55], v[196:199], v[220:223], v[52:55]
    ds_read_b64_tr_b16 v[182:183], v224 offset:6400
    v_mfma_f32_16x16x32_bf16 v[96:99], v[220:223], v[200:203], v[96:99]
    ds_read_b64_tr_b16 v[184:185], v224 offset:10240
    v_mfma_f32_16x16x32_bf16 v[140:143], v[204:207], v[220:223], v[140:143]
    s_waitcnt lgkmcnt(7)
    v_mfma_f32_16x16x32_bf16 v[12:15], v[192:195], v[208:211], v[12:15]
    ds_read_b128 v[220:223], v239 offset:12288
    v_mfma_f32_16x16x32_bf16 v[56:59], v[196:199], v[208:211], v[56:59]
    ds_read_b64_tr_b16 v[186:187], v224 offset:11520
    v_mfma_f32_16x16x32_bf16 v[100:103], v[208:211], v[200:203], v[100:103]
    v_mfma_f32_16x16x32_bf16 v[144:147], v[204:207], v[208:211], v[144:147]
    s_waitcnt lgkmcnt(7)
    v_mfma_f32_16x16x32_bf16 v[16:19], v[192:195], v[212:215], v[16:19]
    ds_read_b128 v[208:211], v239 offset:14336
    v_mfma_f32_16x16x32_bf16 v[60:63], v[196:199], v[212:215], v[60:63]
    ds_read_b64_tr_b16 v[188:189], v225 offset:0
    v_mfma_f32_16x16x32_bf16 v[104:107], v[212:215], v[200:203], v[104:107]
    v_mfma_f32_16x16x32_bf16 v[148:151], v[204:207], v[212:215], v[148:151]
    s_waitcnt lgkmcnt(6)
    v_mfma_f32_16x16x32_bf16 v[20:23], v[192:195], v[216:219], v[20:23]
    ds_read_b128 v[212:215], v239 offset:16384
    v_mfma_f32_16x16x32_bf16 v[64:67], v[196:199], v[216:219], v[64:67]
    ds_read_b64_tr_b16 v[190:191], v225 offset:1280
    v_mfma_f32_16x16x32_bf16 v[108:111], v[216:219], v[200:203], v[108:111]
    v_mfma_f32_16x16x32_bf16 v[152:155], v[204:207], v[216:219], v[152:155]
    s_waitcnt lgkmcnt(5)
    v_mfma_f32_16x16x32_bf16 v[24:27], v[192:195], v[220:223], v[24:27]
    ds_read_b128 v[216:219], v239 offset:18432
    v_mfma_f32_16x16x32_bf16 v[68:71], v[196:199], v[220:223], v[68:71]
    v_mfma_f32_16x16x32_bf16 v[112:115], v[220:223], v[200:203], v[112:115]
    v_mfma_f32_16x16x32_bf16 v[156:159], v[204:207], v[220:223], v[156:159]
    s_waitcnt lgkmcnt(4)
    v_mfma_f32_16x16x32_bf16 v[28:31], v[192:195], v[208:211], v[28:31]
    ds_read_b128 v[220:223], v239 offset:20480
    v_mfma_f32_16x16x32_bf16 v[72:75], v[196:199], v[208:211], v[72:75]
    v_mfma_f32_16x16x32_bf16 v[116:119], v[208:211], v[200:203], v[116:119]
    v_mfma_f32_16x16x32_bf16 v[160:163], v[204:207], v[208:211], v[160:163]
    s_waitcnt lgkmcnt(3)
    v_mfma_f32_16x16x32_bf16 v[32:35], v[192:195], v[212:215], v[32:35]
    ds_read_b128 v[208:211], v238 offset:0
    v_mfma_f32_16x16x32_bf16 v[76:79], v[196:199], v[212:215], v[76:79]
    v_add_u32 v239, s60, v241
    v_mfma_f32_16x16x32_bf16 v[120:123], v[212:215], v[200:203], v[120:123]
    v_mfma_f32_16x16x32_bf16 v[164:167], v[204:207], v[212:215], v[164:167]
    s_waitcnt lgkmcnt(2)
    v_mfma_f32_16x16x32_bf16 v[36:39], v[192:195], v[216:219], v[36:39]
    ds_read_b128 v[212:215], v238 offset:2048
    v_mfma_f32_16x16x32_bf16 v[80:83], v[196:199], v[216:219], v[80:83]
    s_add_u32 s61, s61, 1
    s_cmp_lt_u32 s61, 5
    v_mfma_f32_16x16x32_bf16 v[124:127], v[216:219], v[200:203], v[124:127]
    v_mfma_f32_16x16x32_bf16 v[168:171], v[204:207], v[216:219], v[168:171]
    s_waitcnt lgkmcnt(2)
    v_mfma_f32_16x16x32_bf16 v[40:43], v[192:195], v[220:223], v[40:43]
    ds_read_b128 v[216:219], v238 offset:4096
    v_mfma_f32_16x16x32_bf16 v[84:87], v[196:199], v[220:223], v[84:87]
    s_waitcnt lgkmcnt(2)
    v_cndmask_b32 v208, v208, v242, s[64:65]
    v_cndmask_b32 v209, v209, v242, s[64:65]
    v_mfma_f32_16x16x32_bf16 v[128:131], v[220:223], v[200:203], v[128:131]
    v_cndmask_b32 v210, v210, v242, s[64:65]
    v_cndmask_b32 v211, v211, v242, s[64:65]
    v_mfma_f32_16x16x32_bf16 v[172:175], v[204:207], v[220:223], v[172:175]
    s_cbranch_scc1 cq_loop
    s_waitcnt lgkmcnt(0)
    v_mov_b32 v246, 160260
    v_mov_b32 v247, 1
    s_mov_b64 exec, 1
    ds_add_u32 v246, v247
    s_mov_b64 exec, -1
    ds_read_b64 v[176:177], v248 offset:0
    ds_read_b64 v[178:179], v248 offset:256
    ds_read_b64 v[180:181], v248 offset:512
    ds_read_b64 v[182:183], v248 offset:768
    ds_read_b64 v[184:185], v248 offset:1024
    ds_read_b64 v[186:187], v248 offset:1280
    ds_read_b64 v[188:189], v248 offset:1536
    ds_read_b64 v[190:191], v248 offset:1792
    ds_read_b64 v[192:193], v248 offset:2048
    ds_read_b64 v[194:195], v248 offset:2304
    ds_read_b64 v[196:197], v248 offset:2560
    ds_read_b128 v[212:215], v230 offset:0
    ds_read_b128 v[216:219], v230 offset:768
    ds_read_b128 v[220:223], v230 offset:64
    ds_read_b128 v[224:227], v230 offset:832
    v_mov_b32_dpp v198, v0 row_newbcast:0 row_mask:0xf bank_mask:0xf
    v_mov_b32_dpp v199, v1 row_newbcast:0 row_mask:0xf bank_mask:0xf
    v_mov_b32_dpp v200, v2 row_newbcast:0 row_mask:0xf bank_mask:0xf
    v_mov_b32_dpp v201, v3 row_newbcast:0 row_mask:0xf bank_mask:0xf
    v_mov_b32_dpp v202, v44 row_newbcast:0 row_mask:0xf bank_mask:0xf
    v_mov_b32_dpp v203, v45 row_newbcast:0 row_mask:0xf bank_mask:0xf
    v_mov_b32_dpp v204, v46 row_newbcast:0 row_mask:0xf bank_mask:0xf
    v_mov_b32_dpp v205, v47 row_newbcast:0 row_mask:0xf bank_mask:0xf
    v_mov_b32_dpp v206, v132 row_newbcast:0 row_mask:0xf bank_mask:0xf
    v_mov_b32_dpp v207, v133 row_newbcast:0 row_mask:0xf bank_mask:0xf
    v_mov_b32_dpp v208, v134 row_newbcast:0 row_mask:0xf bank_mask:0xf
    v_mov_b32_dpp v209, v135 row_newbcast:0 row_mask:0xf bank_mask:0xf
    v_mov_b32 v210, v88
    v_mov_b32 v211, v88
    s_nop 1
    v_permlane16_swap_b32 v210, v211
    v_mov_b32 v211, v210
    s_nop 1
    v_permlane32_swap_b32 v210, v211
    s_waitcnt lgkmcnt(2)
    ds_read_b128 v[238:241], v230 offset:128
    ds_read_b128 v[250:253], v230 offset:896
    v_pk_fma_f32 v[44:45], v[202:203], v[176:177], v[44:45] op_sel:[0,0,0] op_sel_hi:[1,0,1]
    v_pk_fma_f32 v[46:47], v[204:205], v[176:177], v[46:47] op_sel:[0,0,0] op_sel_hi:[1,0,1]
    v_pk_fma_f32 v[132:133], v[206:207], v[176:177], v[132:133] op_sel:[0,0,0] op_sel_hi:[1,0,1]
    v_pk_fma_f32 v[134:135], v[208:209], v[176:177], v[134:135] op_sel:[0,0,0] op_sel_hi:[1,0,1]
    v_pk_fma_f32 v[88:89], v[212:213], v[210:211], v[88:89] op_sel:[0,0,0] op_sel_hi:[1,0,1]
    v_pk_fma_f32 v[90:91], v[214:215], v[210:211], v[90:91] op_sel:[0,0,0] op_sel_hi:[1,0,1]
    v_pk_mul_f32 v[44:45], v[44:45], v[176:177] op_sel:[0,1] op_sel_hi:[1,1]
    v_pk_mul_f32 v[46:47], v[46:47], v[176:177] op_sel:[0,1] op_sel_hi:[1,1]
    v_pk_mul_f32 v[132:133], v[132:133], v[176:177] op_sel:[0,1] op_sel_hi:[1,1]
    v_pk_mul_f32 v[134:135], v[134:135], v[176:177] op_sel:[0,1] op_sel_hi:[1,1]
    v_pk_mul_f32 v[88:89], v[88:89], v[216:217]
    v_pk_mul_f32 v[90:91], v[90:91], v[218:219]
    v_cvt_pk_bf16_f32 v44, v44, v45
    v_cvt_pk_bf16_f32 v45, v46, v47
    v_cvt_pk_bf16_f32 v2, v132, v133
    v_cvt_pk_bf16_f32 v3, v134, v135
    v_cvt_pk_bf16_f32 v46, v132, v133
    v_cvt_pk_bf16_f32 v47, v134, v135
    v_cvt_pk_bf16_f32 v88, v88, v89
    v_cvt_pk_bf16_f32 v89, v90, v91
    ds_write_b64 v228, v[46:47] offset:0
    s_waitcnt lgkmcnt(3)
    ds_read_b128 v[212:215], v230 offset:192
    ds_read_b128 v[216:219], v230 offset:960
    v_pk_fma_f32 v[4:5], v[198:199], v[178:179], v[4:5] op_sel:[0,0,0] op_sel_hi:[1,0,1]
    v_pk_fma_f32 v[6:7], v[200:201], v[178:179], v[6:7] op_sel:[0,0,0] op_sel_hi:[1,0,1]
    v_pk_fma_f32 v[48:49], v[202:203], v[178:179], v[48:49] op_sel:[0,0,0] op_sel_hi:[1,0,1]
    v_pk_fma_f32 v[50:51], v[204:205], v[178:179], v[50:51] op_sel:[0,0,0] op_sel_hi:[1,0,1]
    v_pk_fma_f32 v[136:137], v[206:207], v[178:179], v[136:137] op_sel:[0,0,0] op_sel_hi:[1,0,1]
    v_pk_fma_f32 v[138:139], v[208:209], v[178:179], v[138:139] op_sel:[0,0,0] op_sel_hi:[1,0,1]
    v_pk_fma_f32 v[92:93], v[220:221], v[210:211], v[92:93] op_sel:[0,0,0] op_sel_hi:[1,0,1]
    v_pk_fma_f32 v[94:95], v[222:223], v[210:211], v[94:95] op_sel:[0,0,0] op_sel_hi:[1,0,1]
    v_pk_mul_f32 v[4:5], v[4:5], v[178:179] op_sel:[0,1] op_sel_hi:[1,1]
    v_pk_mul_f32 v[6:7], v[6:7], v[178:179] op_sel:[0,1] op_sel_hi:[1,1]
    v_pk_mul_f32 v[48:49], v[48:49], v[178:179] op_sel:[0,1] op_sel_hi:[1,1]
    v_pk_mul_f32 v[50:51], v[50:51], v[178:179] op_sel:[0,1] op_sel_hi:[1,1]
    v_pk_mul_f32 v[136:137], v[136:137], v[178:179] op_sel:[0,1] op_sel_hi:[1,1]
    v_pk_mul_f32 v[138:139], v[138:139], v[178:179] op_sel:[0,1] op_sel_hi:[1,1]
    v_pk_mul_f32 v[92:93], v[92:93], v[224:225]
    v_pk_mul_f32 v[94:95], v[94:95], v[226:227]
    v_cvt_pk_bf16_f32 v4, v4, v5
    v_cvt_pk_bf16_f32 v5, v6, v7
    v_cvt_pk_bf16_f32 v48, v48, v49
    v_cvt_pk_bf16_f32 v49, v50, v51
    v_cvt_pk_bf16_f32 v6, v136, v137
    v_cvt_pk_bf16_f32 v7, v138, v139
    v_cvt_pk_bf16_f32 v50, v136, v137
    v_cvt_pk_bf16_f32 v51, v138, v139
    v_cvt_pk_bf16_f32 v90, v92, v93
    v_cvt_pk_bf16_f32 v91, v94, v95
    ds_write_b64 v228, v[50:51] offset:128
    s_waitcnt lgkmcnt(4)
    ds_read_b128 v[220:223], v230 offset:256
    ds_read_b128 v[224:227], v230 offset:1024
    v_pk_fma_f32 v[8:9], v[198:199], v[180:181], v[8:9] op_sel:[0,0,0] op_sel_hi:[1,0,1]
    v_pk_fma_f32 v[10:11], v[200:201], v[180:181], v[10:11] op_sel:[0,0,0] op_sel_hi:[1,0,1]
    v_pk_fma_f32 v[52:53], v[202:203], v[180:181], v[52:53] op_sel:[0,0,0] op_sel_hi:[1,0,1]
    v_pk_fma_f32 v[54:55], v[204:205], v[180:181], v[54:55] op_sel:[0,0,0] op_sel_hi:[1,0,1]
    v_pk_fma_f32 v[140:141], v[206:207], v[180:181], v[140:141] op_sel:[0,0,0] op_sel_hi:[1,0,1]
    v_pk_fma_f32 v[142:143], v[208:209], v[180:181], v[142:143] op_sel:[0,0,0] op_sel_hi:[1,0,1]
    v_pk_fma_f32 v[96:97], v[238:239], v[210:211], v[96:97] op_sel:[0,0,0] op_sel_hi:[1,0,1]
    v_pk_fma_f32 v[98:99], v[240:241], v[210:211], v[98:99] op_sel:[0,0,0] op_sel_hi:[1,0,1]
    v_pk_mul_f32 v[8:9], v[8:9], v[180:181] op_sel:[0,1] op_sel_hi:[1,1]
    v_pk_mul_f32 v[10:11], v[10:11], v[180:181] op_sel:[0,1] op_sel_hi:[1,1]
    v_pk_mul_f32 v[52:53], v[52:53], v[180:181] op_sel:[0,1] op_sel_hi:[1,1]
    v_pk_mul_f32 v[54:55], v[54:55], v[180:181] op_sel:[0,1] op_sel_hi:[1,1]
    v_pk_mul_f32 v[140:141], v[140:141], v[180:181] op_sel:[0,1] op_sel_hi:[1,1]
    v_pk_mul_f32 v[142:143], v[142:143], v[180:181] op_sel:[0,1] op_sel_hi:[1,1]
    v_pk_mul_f32 v[96:97], v[96:97], v[250:251]
    v_pk_mul_f32 v[98:99], v[98:99], v[252:253]
    v_cvt_pk_bf16_f32 v8, v8, v9
    v_cvt_pk_bf16_f32 v9, v10, v11
    v_cvt_pk_bf16_f32 v52, v52, v53
    v_cvt_pk_bf16_f32 v53, v54, v55
    v_cvt_pk_bf16_f32 v10, v140, v141
    v_cvt_pk_bf16_f32 v11, v142, v143
    v_cvt_pk_bf16_f32 v54, v140, v141
    v_cvt_pk_bf16_f32 v55, v142, v143
    v_cvt_pk_bf16_f32 v92, v96, v97
    v_cvt_pk_bf16_f32 v93, v98, v99
    ds_write_b64 v228, v[54:55] offset:256
    s_waitcnt lgkmcnt(4)
    ds_read_b128 v[238:241], v230 offset:320
    ds_read_b128 v[250:253], v230 offset:1088
    v_pk_fma_f32 v[12:13], v[198:199], v[182:183], v[12:13] op_sel:[0,0,0] op_sel_hi:[1,0,1]
    v_pk_fma_f32 v[14:15], v[200:201], v[182:183], v[14:15] op_sel:[0,0,0] op_sel_hi:[1,0,1]
    v_pk_fma_f32 v[56:57], v[202:203], v[182:183], v[56:57] op_sel:[0,0,0] op_sel_hi:[1,0,1]
    v_pk_fma_f32 v[58:59], v[204:205], v[182:183], v[58:59] op_sel:[0,0,0] op_sel_hi:[1,0,1]
    v_pk_fma_f32 v[144:145], v[206:207], v[182:183], v[144:145] op_sel:[0,0,0] op_sel_hi:[1,0,1]
    v_pk_fma_f32 v[146:147], v[208:209], v[182:183], v[146:147] op_sel:[0,0,0] op_sel_hi:[1,0,1]
    v_pk_fma_f32 v[100:101], v[212:213], v[210:211], v[100:101] op_sel:[0,0,0] op_sel_hi:[1,0,1]
    v_pk_fma_f32 v[102:103], v[214:215], v[210:211], v[102:103] op_sel:[0,0,0] op_sel_hi:[1,0,1]
    v_pk_mul_f32 v[12:13], v[12:13], v[182:183] op_sel:[0,1] op_sel_hi:[1,1]
    v_pk_mul_f32 v[14:15], v[14:15], v[182:183] op_sel:[0,1] op_sel_hi:[1,1]
    v_pk_mul_f32 v[56:57], v[56:57], v[182:183] op_sel:[0,1] op_sel_hi:[1,1]
    v_pk_mul_f32 v[58:59], v[58:59], v[182:183] op_sel:[0,1] op_sel_hi:[1,1]
    v_pk_mul_f32 v[144:145], v[144:145], v[182:183] op_sel:[0,1] op_sel_hi:[1,1]
    v_pk_mul_f32 v[146:147], v[146:147], v[182:183] op_sel:[0,1] op_sel_hi:[1,1]
    v_pk_mul_f32 v[100:101], v[100:101], v[216:217]
    v_pk_mul_f32 v[102:103], v[102:103], v[218:219]
    v_cvt_pk_bf16_f32 v12, v12, v13
    v_cvt_pk_bf16_f32 v13, v14, v15
    v_cvt_pk_bf16_f32 v56, v56, v57
    v_cvt_pk_bf16_f32 v57, v58, v59
    v_cvt_pk_bf16_f32 v14, v144, v145
    v_cvt_pk_bf16_f32 v15, v146, v147
    v_cvt_pk_bf16_f32 v58, v144, v145
    v_cvt_pk_bf16_f32 v59, v146, v147
    v_cvt_pk_bf16_f32 v94, v100, v101
    v_cvt_pk_bf16_f32 v95, v102, v103
    ds_write_b64 v228, v[58:59] offset:384
    s_waitcnt lgkmcnt(4)
    ds_read_b128 v[212:215], v230 offset:384
    ds_read_b128 v[216:219], v230 offset:1152
    v_pk_fma_f32 v[16:17], v[198:199], v[184:185], v[16:17] op_sel:[0,0,0] op_sel_hi:[1,0,1]
    v_pk_fma_f32 v[18:19], v[200:201], v[184:185], v[18:19] op_sel:[0,0,0] op_sel_hi:[1,0,1]
    v_pk_fma_f32 v[60:61], v[202:203], v[184:185], v[60:61] op_sel:[0,0,0] op_sel_hi:[1,0,1]
    v_pk_fma_f32 v[62:63], v[204:205], v[184:185], v[62:63] op_sel:[0,0,0] op_sel_hi:[1,0,1]
    v_pk_fma_f32 v[148:149], v[206:207], v[184:185], v[148:149] op_sel:[0,0,0] op_sel_hi:[1,0,1]
    v_pk_fma_f32 v[150:151], v[208:209], v[184:185], v[150:151] op_sel:[0,0,0] op_sel_hi:[1,0,1]
    v_pk_fma_f32 v[104:105], v[220:221], v[210:211], v[104:105] op_sel:[0,0,0] op_sel_hi:[1,0,1]
    v_pk_fma_f32 v[106:107], v[222:223], v[210:211], v[106:107] op_sel:[0,0,0] op_sel_hi:[1,0,1]
    v_pk_mul_f32 v[16:17], v[16:17], v[184:185] op_sel:[0,1] op_sel_hi:[1,1]
    v_pk_mul_f32 v[18:19], v[18:19], v[184:185] op_sel:[0,1] op_sel_hi:[1,1]
    v_pk_mul_f32 v[60:61], v[60:61], v[184:185] op_sel:[0,1] op_sel_hi:[1,1]
    v_pk_mul_f32 v[62:63], v[62:63], v[184:185] op_sel:[0,1] op_sel_hi:[1,1]
    v_pk_mul_f32 v[148:149], v[148:149], v[184:185] op_sel:[0,1] op_sel_hi:[1,1]
    v_pk_mul_f32 v[150:151], v[150:151], v[184:185] op_sel:[0,1] op_sel_hi:[1,1]
    v_pk_mul_f32 v[104:105], v[104:105], v[224:225]
    v_pk_mul_f32 v[106:107], v[106:107], v[226:227]
    v_cvt_pk_bf16_f32 v16, v16, v17
    v_cvt_pk_bf16_f32 v17, v18, v19
    v_cvt_pk_bf16_f32 v60, v60, v61
    v_cvt_pk_bf16_f32 v61, v62, v63
    v_cvt_pk_bf16_f32 v18, v148, v149
    v_cvt_pk_bf16_f32 v19, v150, v151
    v_cvt_pk_bf16_f32 v62, v148, v149
    v_cvt_pk_bf16_f32 v63, v150, v151
    v_cvt_pk_bf16_f32 v96, v104, v105
    v_cvt_pk_bf16_f32 v97, v106, v107
    ds_write_b64 v228, v[62:63] offset:512
    s_waitcnt lgkmcnt(4)
    ds_read_b128 v[220:223], v230 offset:448
    ds_read_b128 v[224:227], v230 offset:1216
    v_pk_fma_f32 v[20:21], v[198:199], v[186:187], v[20:21] op_sel:[0,0,0] op_sel_hi:[1,0,1]
    v_pk_fma_f32 v[22:23], v[200:201], v[186:187], v[22:23] op_sel:[0,0,0] op_sel_hi:[1,0,1]
    v_pk_fma_f32 v[64:65], v[202:203], v[186:187], v[64:65] op_sel:[0,0,0] op_sel_hi:[1,0,1]
    v_pk_fma_f32 v[66:67], v[204:205], v[186:187], v[66:67] op_sel:[0,0,0] op_sel_hi:[1,0,1]
    v_pk_fma_f32 v[152:153], v[206:207], v[186:187], v[152:153] op_sel:[0,0,0] op_sel_hi:[1,0,1]
    v_pk_fma_f32 v[154:155], v[208:209], v[186:187], v[154:155] op_sel:[0,0,0] op_sel_hi:[1,0,1]
    v_pk_fma_f32 v[108:109], v[238:239], v[210:211], v[108:109] op_sel:[0,0,0] op_sel_hi:[1,0,1]
    v_pk_fma_f32 v[110:111], v[240:241], v[210:211], v[110:111] op_sel:[0,0,0] op_sel_hi:[1,0,1]
    v_pk_mul_f32 v[20:21], v[20:21], v[186:187] op_sel:[0,1] op_sel_hi:[1,1]
    v_pk_mul_f32 v[22:23], v[22:23], v[186:187] op_sel:[0,1] op_sel_hi:[1,1]
    v_pk_mul_f32 v[64:65], v[64:65], v[186:187] op_sel:[0,1] op_sel_hi:[1,1]
    v_pk_mul_f32 v[66:67], v[66:67], v[186:187] op_sel:[0,1] op_sel_hi:[1,1]
    v_pk_mul_f32 v[152:153], v[152:153], v[186:187] op_sel:[0,1] op_sel_hi:[1,1]
    v_pk_mul_f32 v[154:155], v[154:155], v[186:187] op_sel:[0,1] op_sel_hi:[1,1]
    v_pk_mul_f32 v[108:109], v[108:109], v[250:251]
    v_pk_mul_f32 v[110:111], v[110:111], v[252:253]
    v_cvt_pk_bf16_f32 v20, v20, v21
    v_cvt_pk_bf16_f32 v21, v22, v23
    v_cvt_pk_bf16_f32 v64, v64, v65
    v_cvt_pk_bf16_f32 v65, v66, v67
    v_cvt_pk_bf16_f32 v22, v152, v153
    v_cvt_pk_bf16_f32 v23, v154, v155
    v_cvt_pk_bf16_f32 v66, v152, v153
    v_cvt_pk_bf16_f32 v67, v154, v155
    v_cvt_pk_bf16_f32 v98, v108, v109
    v_cvt_pk_bf16_f32 v99, v110, v111
    ds_write_b64 v228, v[66:67] offset:640
    s_waitcnt lgkmcnt(4)
    ds_read_b128 v[238:241], v230 offset:512
    ds_read_b128 v[250:253], v230 offset:1280
    v_pk_fma_f32 v[24:25], v[198:199], v[188:189], v[24:25] op_sel:[0,0,0] op_sel_hi:[1,0,1]
    v_pk_fma_f32 v[26:27], v[200:201], v[188:189], v[26:27] op_sel:[0,0,0] op_sel_hi:[1,0,1]
    v_pk_fma_f32 v[68:69], v[202:203], v[188:189], v[68:69] op_sel:[0,0,0] op_sel_hi:[1,0,1]
    v_pk_fma_f32 v[70:71], v[204:205], v[188:189], v[70:71] op_sel:[0,0,0] op_sel_hi:[1,0,1]
    v_pk_fma_f32 v[156:157], v[206:207], v[188:189], v[156:157] op_sel:[0,0,0] op_sel_hi:[1,0,1]
    v_pk_fma_f32 v[158:159], v[208:209], v[188:189], v[158:159] op_sel:[0,0,0] op_sel_hi:[1,0,1]
    v_pk_fma_f32 v[112:113], v[212:213], v[210:211], v[112:113] op_sel:[0,0,0] op_sel_hi:[1,0,1]
    v_pk_fma_f32 v[114:115], v[214:215], v[210:211], v[114:115] op_sel:[0,0,0] op_sel_hi:[1,0,1]
    v_pk_mul_f32 v[24:25], v[24:25], v[188:189] op_sel:[0,1] op_sel_hi:[1,1]
    v_pk_mul_f32 v[26:27], v[26:27], v[188:189] op_sel:[0,1] op_sel_hi:[1,1]
    v_pk_mul_f32 v[68:69], v[68:69], v[188:189] op_sel:[0,1] op_sel_hi:[1,1]
    v_pk_mul_f32 v[70:71], v[70:71], v[188:189] op_sel:[0,1] op_sel_hi:[1,1]
    v_pk_mul_f32 v[156:157], v[156:157], v[188:189] op_sel:[0,1] op_sel_hi:[1,1]
    v_pk_mul_f32 v[158:159], v[158:159], v[188:189] op_sel:[0,1] op_sel_hi:[1,1]
    v_pk_mul_f32 v[112:113], v[112:113], v[216:217]
    v_pk_mul_f32 v[114:115], v[114:115], v[218:219]
    v_cvt_pk_bf16_f32 v24, v24, v25
    v_cvt_pk_bf16_f32 v25, v26, v27
    v_cvt_pk_bf16_f32 v68, v68, v69
    v_cvt_pk_bf16_f32 v69, v70, v71
    v_cvt_pk_bf16_f32 v26, v156, v157
    v_cvt_pk_bf16_f32 v27, v158, v159
    v_cvt_pk_bf16_f32 v70, v156, v157
    v_cvt_pk_bf16_f32 v71, v158, v159
    v_cvt_pk_bf16_f32 v100, v112, v113
    v_cvt_pk_bf16_f32 v101, v114, v115
    ds_write_b64 v228, v[70:71] offset:768
    s_waitcnt lgkmcnt(4)
    ds_read_b128 v[212:215], v230 offset:576
    ds_read_b128 v[216:219], v230 offset:1344
    v_pk_fma_f32 v[28:29], v[198:199], v[190:191], v[28:29] op_sel:[0,0,0] op_sel_hi:[1,0,1]
    v_pk_fma_f32 v[30:31], v[200:201], v[190:191], v[30:31] op_sel:[0,0,0] op_sel_hi:[1,0,1]
    v_pk_fma_f32 v[72:73], v[202:203], v[190:191], v[72:73] op_sel:[0,0,0] op_sel_hi:[1,0,1]
    v_pk_fma_f32 v[74:75], v[204:205], v[190:191], v[74:75] op_sel:[0,0,0] op_sel_hi:[1,0,1]
    v_pk_fma_f32 v[160:161], v[206:207], v[190:191], v[160:161] op_sel:[0,0,0] op_sel_hi:[1,0,1]
    v_pk_fma_f32 v[162:163], v[208:209], v[190:191], v[162:163] op_sel:[0,0,0] op_sel_hi:[1,0,1]
    v_pk_fma_f32 v[116:117], v[220:221], v[210:211], v[116:117] op_sel:[0,0,0] op_sel_hi:[1,0,1]
    v_pk_fma_f32 v[118:119], v[222:223], v[210:211], v[118:119] op_sel:[0,0,0] op_sel_hi:[1,0,1]
    v_pk_mul_f32 v[28:29], v[28:29], v[190:191] op_sel:[0,1] op_sel_hi:[1,1]
    v_pk_mul_f32 v[30:31], v[30:31], v[190:191] op_sel:[0,1] op_sel_hi:[1,1]
    v_pk_mul_f32 v[72:73], v[72:73], v[190:191] op_sel:[0,1] op_sel_hi:[1,1]
    v_pk_mul_f32 v[74:75], v[74:75], v[190:191] op_sel:[0,1] op_sel_hi:[1,1]
    v_pk_mul_f32 v[160:161], v[160:161], v[190:191] op_sel:[0,1] op_sel_hi:[1,1]
    v_pk_mul_f32 v[162:163], v[162:163], v[190:191] op_sel:[0,1] op_sel_hi:[1,1]
    v_pk_mul_f32 v[116:117], v[116:117], v[224:225]
    v_pk_mul_f32 v[118:119], v[118:119], v[226:227]
    v_cvt_pk_bf16_f32 v28, v28, v29
    v_cvt_pk_bf16_f32 v29, v30, v31
    v_cvt_pk_bf16_f32 v72, v72, v73
    v_cvt_pk_bf16_f32 v73, v74, v75
    v_cvt_pk_bf16_f32 v30, v160, v161
    v_cvt_pk_bf16_f32 v31, v162, v163
    v_cvt_pk_bf16_f32 v74, v160, v161
    v_cvt_pk_bf16_f32 v75, v162, v163
    v_cvt_pk_bf16_f32 v102, v116, v117
    v_cvt_pk_bf16_f32 v103, v118, v119
    ds_write_b64 v228, v[74:75] offset:896
    s_waitcnt lgkmcnt(4)
    ds_read_b128 v[220:223], v230 offset:640
    ds_read_b128 v[224:227], v230 offset:1408
    v_pk_fma_f32 v[32:33], v[198:199], v[192:193], v[32:33] op_sel:[0,0,0] op_sel_hi:[1,0,1]
    v_pk_fma_f32 v[34:35], v[200:201], v[192:193], v[34:35] op_sel:[0,0,0] op_sel_hi:[1,0,1]
    v_pk_fma_f32 v[76:77], v[202:203], v[192:193], v[76:77] op_sel:[0,0,0] op_sel_hi:[1,0,1]
    v_pk_fma_f32 v[78:79], v[204:205], v[192:193], v[78:79] op_sel:[0,0,0] op_sel_hi:[1,0,1]
    v_pk_fma_f32 v[164:165], v[206:207], v[192:193], v[164:165] op_sel:[0,0,0] op_sel_hi:[1,0,1]
    v_pk_fma_f32 v[166:167], v[208:209], v[192:193], v[166:167] op_sel:[0,0,0] op_sel_hi:[1,0,1]
    v_pk_fma_f32 v[120:121], v[238:239], v[210:211], v[120:121] op_sel:[0,0,0] op_sel_hi:[1,0,1]
    v_pk_fma_f32 v[122:123], v[240:241], v[210:211], v[122:123] op_sel:[0,0,0] op_sel_hi:[1,0,1]
    v_pk_mul_f32 v[32:33], v[32:33], v[192:193] op_sel:[0,1] op_sel_hi:[1,1]
    v_pk_mul_f32 v[34:35], v[34:35], v[192:193] op_sel:[0,1] op_sel_hi:[1,1]
    v_pk_mul_f32 v[76:77], v[76:77], v[192:193] op_sel:[0,1] op_sel_hi:[1,1]
    v_pk_mul_f32 v[78:79], v[78:79], v[192:193] op_sel:[0,1] op_sel_hi:[1,1]
    v_pk_mul_f32 v[164:165], v[164:165], v[192:193] op_sel:[0,1] op_sel_hi:[1,1]
    v_pk_mul_f32 v[166:167], v[166:167], v[192:193] op_sel:[0,1] op_sel_hi:[1,1]
    v_pk_mul_f32 v[120:121], v[120:121], v[250:251]
    v_pk_mul_f32 v[122:123], v[122:123], v[252:253]
    v_cvt_pk_bf16_f32 v32, v32, v33
    v_cvt_pk_bf16_f32 v33, v34, v35
    v_cvt_pk_bf16_f32 v76, v76, v77
    v_cvt_pk_bf16_f32 v77, v78, v79
    v_cvt_pk_bf16_f32 v34, v164, v165
    v_cvt_pk_bf16_f32 v35, v166, v167
    v_cvt_pk_bf16_f32 v78, v164, v165
    v_cvt_pk_bf16_f32 v79, v166, v167
    v_cvt_pk_bf16_f32 v104, v120, v121
    v_cvt_pk_bf16_f32 v105, v122, v123
    ds_write_b64 v228, v[78:79] offset:1024
    s_waitcnt lgkmcnt(4)
    v_pk_fma_f32 v[36:37], v[198:199], v[194:195], v[36:37] op_sel:[0,0,0] op_sel_hi:[1,0,1]
    v_pk_fma_f32 v[38:39], v[200:201], v[194:195], v[38:39] op_sel:[0,0,0] op_sel_hi:[1,0,1]
    v_pk_fma_f32 v[80:81], v[202:203], v[194:195], v[80:81] op_sel:[0,0,0] op_sel_hi:[1,0,1]
    v_pk_fma_f32 v[82:83], v[204:205], v[194:195], v[82:83] op_sel:[0,0,0] op_sel_hi:[1,0,1]
    v_pk_fma_f32 v[168:169], v[206:207], v[194:195], v[168:169] op_sel:[0,0,0] op_sel_hi:[1,0,1]
    v_pk_fma_f32 v[170:171], v[208:209], v[194:195], v[170:171] op_sel:[0,0,0] op_sel_hi:[1,0,1]
    v_pk_fma_f32 v[124:125], v[212:213], v[210:211], v[124:125] op_sel:[0,0,0] op_sel_hi:[1,0,1]
    v_pk_fma_f32 v[126:127], v[214:215], v[210:211], v[126:127] op_sel:[0,0,0] op_sel_hi:[1,0,1]
    v_pk_mul_f32 v[36:37], v[36:37], v[194:195] op_sel:[0,1] op_sel_hi:[1,1]
    v_pk_mul_f32 v[38:39], v[38:39], v[194:195] op_sel:[0,1] op_sel_hi:[1,1]
    v_pk_mul_f32 v[80:81], v[80:81], v[194:195] op_sel:[0,1] op_sel_hi:[1,1]
    v_pk_mul_f32 v[82:83], v[82:83], v[194:195] op_sel:[0,1] op_sel_hi:[1,1]
    v_pk_mul_f32 v[168:169], v[168:169], v[194:195] op_sel:[0,1] op_sel_hi:[1,1]
    v_pk_mul_f32 v[170:171], v[170:171], v[194:195] op_sel:[0,1] op_sel_hi:[1,1]
    v_pk_mul_f32 v[124:125], v[124:125], v[216:217]
    v_pk_mul_f32 v[126:127], v[126:127], v[218:219]
    v_cvt_pk_bf16_f32 v36, v36, v37
    v_cvt_pk_bf16_f32 v37, v38, v39
    v_cvt_pk_bf16_f32 v80, v80, v81
    v_cvt_pk_bf16_f32 v81, v82, v83
    v_cvt_pk_bf16_f32 v38, v168, v169
    v_cvt_pk_bf16_f32 v39, v170, v171
    v_cvt_pk_bf16_f32 v82, v168, v169
    v_cvt_pk_bf16_f32 v83, v170, v171
    v_cvt_pk_bf16_f32 v106, v124, v125
    v_cvt_pk_bf16_f32 v107, v126, v127
    ds_write_b64 v228, v[82:83] offset:1152
    s_waitcnt lgkmcnt(2)
    v_pk_fma_f32 v[40:41], v[198:199], v[196:197], v[40:41] op_sel:[0,0,0] op_sel_hi:[1,0,1]
    v_pk_fma_f32 v[42:43], v[200:201], v[196:197], v[42:43] op_sel:[0,0,0] op_sel_hi:[1,0,1]
    v_pk_fma_f32 v[84:85], v[202:203], v[196:197], v[84:85] op_sel:[0,0,0] op_sel_hi:[1,0,1]
    v_pk_fma_f32 v[86:87], v[204:205], v[196:197], v[86:87] op_sel:[0,0,0] op_sel_hi:[1,0,1]
    v_pk_fma_f32 v[172:173], v[206:207], v[196:197], v[172:173] op_sel:[0,0,0] op_sel_hi:[1,0,1]
    v_pk_fma_f32 v[174:175], v[208:209], v[196:197], v[174:175] op_sel:[0,0,0] op_sel_hi:[1,0,1]
    v_pk_fma_f32 v[128:129], v[220:221], v[210:211], v[128:129] op_sel:[0,0,0] op_sel_hi:[1,0,1]
    v_pk_fma_f32 v[130:131], v[222:223], v[210:211], v[130:131] op_sel:[0,0,0] op_sel_hi:[1,0,1]
    v_pk_mul_f32 v[40:41], v[40:41], v[196:197] op_sel:[0,1] op_sel_hi:[1,1]
    v_pk_mul_f32 v[42:43], v[42:43], v[196:197] op_sel:[0,1] op_sel_hi:[1,1]
    v_pk_mul_f32 v[84:85], v[84:85], v[196:197] op_sel:[0,1] op_sel_hi:[1,1]
    v_pk_mul_f32 v[86:87], v[86:87], v[196:197] op_sel:[0,1] op_sel_hi:[1,1]
    v_pk_mul_f32 v[172:173], v[172:173], v[196:197] op_sel:[0,1] op_sel_hi:[1,1]
    v_pk_mul_f32 v[174:175], v[174:175], v[196:197] op_sel:[0,1] op_sel_hi:[1,1]
    v_pk_mul_f32 v[128:129], v[128:129], v[224:225]
    v_pk_mul_f32 v[130:131], v[130:131], v[226:227]
    v_cvt_pk_bf16_f32 v40, v40, v41
    v_cvt_pk_bf16_f32 v41, v42, v43
    v_cvt_pk_bf16_f32 v84, v84, v85
    v_cvt_pk_bf16_f32 v85, v86, v87
    v_cvt_pk_bf16_f32 v42, v172, v173
    v_cvt_pk_bf16_f32 v43, v174, v175
    v_cvt_pk_bf16_f32 v86, v172, v173
    v_cvt_pk_bf16_f32 v87, v174, v175
    v_cvt_pk_bf16_f32 v108, v128, v129
    v_cvt_pk_bf16_f32 v109, v130, v131
    ds_write_b64 v228, v[86:87] offset:1280
    v_permlane16_swap_b32 v2, v46
    v_permlane16_swap_b32 v3, v47
    v_permlane16_swap_b32 v6, v50
    v_permlane16_swap_b32 v7, v51
    v_permlane16_swap_b32 v10, v54
    v_permlane16_swap_b32 v11, v55
    v_permlane16_swap_b32 v14, v58
    v_permlane16_swap_b32 v15, v59
    v_permlane16_swap_b32 v18, v62
    v_permlane16_swap_b32 v19, v63
    v_permlane16_swap_b32 v22, v66
    v_permlane16_swap_b32 v23, v67
    v_permlane16_swap_b32 v26, v70
    v_permlane16_swap_b32 v27, v71
    v_permlane16_swap_b32 v30, v74
    v_permlane16_swap_b32 v31, v75
    v_permlane16_swap_b32 v34, v78
    v_permlane16_swap_b32 v35, v79
    v_permlane16_swap_b32 v38, v82
    v_permlane16_swap_b32 v39, v83
    v_permlane16_swap_b32 v42, v86
    v_permlane16_swap_b32 v43, v87
    s_waitcnt lgkmcnt(0)
    ds_read_b64_tr_b16 v[110:111], v229 offset:0
    ds_read_b64_tr_b16 v[112:113], v229 offset:128
    ds_read_b64_tr_b16 v[114:115], v229 offset:256
    ds_read_b64_tr_b16 v[116:117], v229 offset:384
    ds_read_b64_tr_b16 v[118:119], v229 offset:512
    ds_read_b64_tr_b16 v[120:121], v229 offset:640
    ds_read_b64_tr_b16 v[122:123], v229 offset:768
    ds_read_b64_tr_b16 v[124:125], v229 offset:896
    ds_read_b64_tr_b16 v[126:127], v229 offset:1024
    ds_read_b64_tr_b16 v[128:129], v229 offset:1152
    ds_read_b64_tr_b16 v[130:131], v229 offset:1280
    s_mov_b64 exec, s[26:27]
    v_mov_b64 v[6:7], 0
    v_mov_b64 v[10:11], 0
    v_mov_b64 v[14:15], 0
    v_mov_b64 v[18:19], 0
    v_mov_b64 v[22:23], 0
    v_mov_b64 v[26:27], 0
    v_mov_b64 v[30:31], 0
    v_mov_b64 v[34:35], 0
    v_mov_b64 v[38:39], 0
    v_mov_b64 v[42:43], 0
    s_mov_b64 exec, s[24:25]
    v_mfma_f32_16x16x32_bf16 v[132:135], v[48:51], v[4:7], 0
    v_mfma_f32_16x16x32_bf16 v[136:139], v[44:47], v[4:7], 0
    v_mfma_f32_16x16x32_bf16 v[140:143], v[52:55], v[8:11], 0
    v_mfma_f32_16x16x32_bf16 v[144:147], v[48:51], v[8:11], 0
    v_mfma_f32_16x16x32_bf16 v[148:151], v[56:59], v[12:15], 0
    v_mfma_f32_16x16x32_bf16 v[152:155], v[52:55], v[12:15], 0
    v_mfma_f32_16x16x32_bf16 v[156:159], v[60:63], v[16:19], 0
    v_mfma_f32_16x16x32_bf16 v[160:163], v[56:59], v[16:19], 0
    s_nop 0
    v_cndmask_b32 v132, v132, v133, s[74:75]
    v_cndmask_b32 v134, v134, v135, s[74:75]
    v_cndmask_b32 v136, v136, v137, s[74:75]
    v_cndmask_b32 v138, v138, v139, s[74:75]
    v_mfma_f32_16x16x32_bf16 v[164:167], v[64:67], v[20:23], 0
    v_mfma_f32_16x16x32_bf16 v[168:171], v[60:63], v[20:23], 0
    v_cndmask_b32 v140, v140, v141, s[74:75]
    v_cndmask_b32 v142, v142, v143, s[74:75]
    v_cndmask_b32 v144, v144, v145, s[74:75]
    v_cndmask_b32 v146, v146, v147, s[74:75]
    v_mfma_f32_16x16x32_bf16 v[172:175], v[68:71], v[24:27], 0
    v_mfma_f32_16x16x32_bf16 v[176:179], v[64:67], v[24:27], 0
    v_cndmask_b32 v148, v148, v149, s[74:75]
    v_cndmask_b32 v150, v150, v151, s[74:75]
    v_cndmask_b32 v152, v152, v153, s[74:75]
    v_cndmask_b32 v154, v154, v155, s[74:75]
    v_mfma_f32_16x16x32_bf16 v[180:183], v[72:75], v[28:31], 0
    v_mfma_f32_16x16x32_bf16 v[184:187], v[68:71], v[28:31], 0
    v_cndmask_b32 v156, v156, v157, s[74:75]
    v_cndmask_b32 v158, v158, v159, s[74:75]
    v_cndmask_b32 v160, v160, v161, s[74:75]
    v_cndmask_b32 v162, v162, v163, s[74:75]
    v_mfma_f32_16x16x32_bf16 v[188:191], v[76:79], v[32:35], 0
    v_mfma_f32_16x16x32_bf16 v[192:195], v[72:75], v[32:35], 0
    v_cndmask_b32 v164, v164, v165, s[74:75]
    v_cndmask_b32 v166, v166, v167, s[74:75]
    v_cndmask_b32 v168, v168, v169, s[74:75]
    v_cndmask_b32 v170, v170, v171, s[74:75]
    v_mfma_f32_16x16x32_bf16 v[196:199], v[80:83], v[36:39], 0
    v_mfma_f32_16x16x32_bf16 v[200:203], v[76:79], v[36:39], 0
    v_cndmask_b32 v172, v172, v173, s[74:75]
    v_cndmask_b32 v174, v174, v175, s[74:75]
    v_cndmask_b32 v176, v176, v177, s[74:75]
    v_cndmask_b32 v178, v178, v179, s[74:75]
    v_mfma_f32_16x16x32_bf16 v[204:207], v[84:87], v[40:43], 0
    v_mfma_f32_16x16x32_bf16 v[208:211], v[80:83], v[40:43], 0
    v_cndmask_b32 v180, v180, v181, s[74:75]
    v_cndmask_b32 v182, v182, v183, s[74:75]
    v_cndmask_b32 v184, v184, v185, s[74:75]
    v_cndmask_b32 v186, v186, v187, s[74:75]
    v_cndmask_b32 v188, v188, v189, s[74:75]
    v_cndmask_b32 v190, v190, v191, s[74:75]
    v_cndmask_b32 v192, v192, v193, s[74:75]
    v_cndmask_b32 v194, v194, v195, s[74:75]
    v_cndmask_b32 v196, v196, v197, s[74:75]
    v_cndmask_b32 v198, v198, v199, s[74:75]
    v_cndmask_b32 v200, v200, v201, s[74:75]
    v_cndmask_b32 v202, v202, v203, s[74:75]
    v_cndmask_b32 v204, v204, v205, s[74:75]
    v_cndmask_b32 v206, v206, v207, s[74:75]
    v_cndmask_b32 v208, v208, v209, s[74:75]
    v_cndmask_b32 v210, v210, v211, s[74:75]
    s_cmp_lg_u32 s56, 0
    s_cbranch_scc1 cq_nofix
    v_mov_b32 v136, 0xf149f2ca
    v_mov_b32 v138, 0xf149f2ca
cq_nofix:
    v_cndmask_b32 v44, v136, v132, s[76:77]
    v_cndmask_b32 v45, v138, v134, s[78:79]
    v_cndmask_b32 v46, v144, v140, s[76:77]
    v_cndmask_b32 v47, v146, v142, s[78:79]
    v_cndmask_b32 v48, v152, v148, s[76:77]
    v_cndmask_b32 v49, v154, v150, s[78:79]
    v_cndmask_b32 v50, v160, v156, s[76:77]
    v_cndmask_b32 v51, v162, v158, s[78:79]
    v_cndmask_b32 v52, v168, v164, s[76:77]
    v_cndmask_b32 v53, v170, v166, s[78:79]
    v_cndmask_b32 v54, v176, v172, s[76:77]
    v_cndmask_b32 v55, v178, v174, s[78:79]
    v_cndmask_b32 v56, v184, v180, s[76:77]
    v_cndmask_b32 v57, v186, v182, s[78:79]
    v_cndmask_b32 v58, v192, v188, s[76:77]
    v_cndmask_b32 v59, v194, v190, s[78:79]
    v_cndmask_b32 v60, v200, v196, s[76:77]
    v_cndmask_b32 v61, v202, v198, s[78:79]
    v_cndmask_b32 v62, v208, v204, s[76:77]
    v_cndmask_b32 v63, v210, v206, s[78:79]
    v_max_f32 v64, v44, v45
    v_max_f32 v65, v46, v47
    v_max_f32 v66, v48, v49
    v_max_f32 v67, v50, v51
    v_max_f32 v68, v52, v53
    v_max_f32 v69, v54, v55
    v_max_f32 v70, v56, v57
    v_max_f32 v71, v58, v59
    v_max_f32 v72, v60, v61
    v_max_f32 v73, v62, v63
    v_mov_b32 v74, 1.0
    v_mov_b32 v75, 1.0
    s_mov_b32 s68, 0x3ea52b5c
    s_mov_b32 s69, 0x3ea52b5c
    v_permlane16_swap_b32 v64, v65
    v_permlane16_swap_b32 v66, v67
    v_permlane16_swap_b32 v68, v69
    v_permlane16_swap_b32 v70, v71
    v_permlane16_swap_b32 v72, v73
    v_permlane16_swap_b32 v74, v75
    v_max_f32 v64, v64, v65
    v_max_f32 v66, v66, v67
    v_max_f32 v68, v68, v69
    v_max_f32 v70, v70, v71
    v_max_f32 v72, v72, v73
    v_max_f32 v74, v74, v75
    v_permlane32_swap_b32 v64, v66
    v_permlane32_swap_b32 v68, v70
    v_permlane32_swap_b32 v72, v74
    v_max_f32 v64, v64, v66
    v_max_f32 v68, v68, v70
    v_max_f32 v72, v72, v74
    v_mul_f32 v64, s68, v64
    v_mul_f32 v68, s68, v68
    v_mul_f32 v72, s68, v72
    v_mov_b32 v66, v64
    v_mov_b32 v70, v68
    v_mov_b32 v74, v72
    v_permlane32_swap_b32 v64, v66
    v_permlane32_swap_b32 v68, v70
    v_permlane32_swap_b32 v72, v74
    v_mov_b32 v65, v64
    v_mov_b32 v67, v66
    v_mov_b32 v69, v68
    v_mov_b32 v71, v70
    v_mov_b32 v73, v72
    v_mov_b32 v75, v74
    v_permlane16_swap_b32 v64, v65
    v_permlane16_swap_b32 v66, v67
    v_permlane16_swap_b32 v68, v69
    v_permlane16_swap_b32 v70, v71
    v_permlane16_swap_b32 v72, v73
    v_permlane16_swap_b32 v74, v75
    v_pk_fma_f32 v[44:45], v[44:45], s[68:69], v[64:65] op_sel:[0,0,0] op_sel_hi:[1,1,0] neg_lo:[0,0,1] neg_hi:[0,0,1]
    v_pk_fma_f32 v[46:47], v[46:47], s[68:69], v[64:65] op_sel:[0,0,1] op_sel_hi:[1,1,1] neg_lo:[0,0,1] neg_hi:[0,0,1]
    v_pk_fma_f32 v[48:49], v[48:49], s[68:69], v[66:67] op_sel:[0,0,0] op_sel_hi:[1,1,0] neg_lo:[0,0,1] neg_hi:[0,0,1]
    v_pk_fma_f32 v[50:51], v[50:51], s[68:69], v[66:67] op_sel:[0,0,1] op_sel_hi:[1,1,1] neg_lo:[0,0,1] neg_hi:[0,0,1]
    v_pk_fma_f32 v[52:53], v[52:53], s[68:69], v[68:69] op_sel:[0,0,0] op_sel_hi:[1,1,0] neg_lo:[0,0,1] neg_hi:[0,0,1]
    v_pk_fma_f32 v[54:55], v[54:55], s[68:69], v[68:69] op_sel:[0,0,1] op_sel_hi:[1,1,1] neg_lo:[0,0,1] neg_hi:[0,0,1]
    v_pk_fma_f32 v[56:57], v[56:57], s[68:69], v[70:71] op_sel:[0,0,0] op_sel_hi:[1,1,0] neg_lo:[0,0,1] neg_hi:[0,0,1]
    v_pk_fma_f32 v[58:59], v[58:59], s[68:69], v[70:71] op_sel:[0,0,1] op_sel_hi:[1,1,1] neg_lo:[0,0,1] neg_hi:[0,0,1]
    v_pk_fma_f32 v[60:61], v[60:61], s[68:69], v[72:73] op_sel:[0,0,0] op_sel_hi:[1,1,0] neg_lo:[0,0,1] neg_hi:[0,0,1]
    v_pk_fma_f32 v[62:63], v[62:63], s[68:69], v[72:73] op_sel:[0,0,1] op_sel_hi:[1,1,1] neg_lo:[0,0,1] neg_hi:[0,0,1]
    v_exp_f32 v44, v44
    v_exp_f32 v45, v45
    v_exp_f32 v46, v46
    v_exp_f32 v47, v47
    v_exp_f32 v48, v48
    v_exp_f32 v49, v49
    v_exp_f32 v50, v50
    v_exp_f32 v51, v51
    v_exp_f32 v52, v52
    v_exp_f32 v53, v53
    v_exp_f32 v54, v54
    v_exp_f32 v55, v55
    v_exp_f32 v56, v56
    v_exp_f32 v57, v57
    v_exp_f32 v58, v58
    v_exp_f32 v59, v59
    v_exp_f32 v60, v60
    v_exp_f32 v61, v61
    v_exp_f32 v62, v62
    v_exp_f32 v63, v63
    v_add_f32 v64, v44, v45
    v_add_f32 v65, v46, v47
    v_add_f32 v66, v48, v49
    v_add_f32 v67, v50, v51
    v_add_f32 v68, v52, v53
    v_add_f32 v69, v54, v55
    v_add_f32 v70, v56, v57
    v_add_f32 v71, v58, v59
    v_add_f32 v72, v60, v61
    v_add_f32 v73, v62, v63
    v_permlane16_swap_b32 v64, v65
    v_permlane16_swap_b32 v66, v67
    v_permlane16_swap_b32 v68, v69
    v_permlane16_swap_b32 v70, v71
    v_permlane16_swap_b32 v72, v73
    v_permlane16_swap_b32 v74, v75
    v_add_f32 v64, v64, v65
    v_add_f32 v66, v66, v67
    v_add_f32 v68, v68, v69
    v_add_f32 v70, v70, v71
    v_add_f32 v72, v72, v73
    v_add_f32 v74, v74, v75
    v_permlane32_swap_b32 v64, v66
    v_permlane32_swap_b32 v68, v70
    v_permlane32_swap_b32 v72, v74
    v_add_f32 v64, v64, v66
    v_add_f32 v68, v68, v70
    v_add_f32 v72, v72, v74
    v_rcp_f32 v64, v64
    v_rcp_f32 v68, v68
    v_rcp_f32 v72, v72
    v_mov_b32 v66, v64
    v_mov_b32 v70, v68
    v_mov_b32 v74, v72
    v_permlane32_swap_b32 v64, v66
    v_permlane32_swap_b32 v68, v70
    v_permlane32_swap_b32 v72, v74
    v_mov_b32 v65, v64
    v_mov_b32 v67, v66
    v_mov_b32 v69, v68
    v_mov_b32 v71, v70
    v_mov_b32 v73, v72
    v_mov_b32 v75, v74
    v_permlane16_swap_b32 v64, v65
    v_permlane16_swap_b32 v66, v67
    v_permlane16_swap_b32 v68, v69
    v_permlane16_swap_b32 v70, v71
    v_permlane16_swap_b32 v72, v73
    v_permlane16_swap_b32 v74, v75
    v_pk_mul_f32 v[44:45], v[44:45], v[64:65] op_sel:[0,0] op_sel_hi:[1,0]
    v_pk_mul_f32 v[46:47], v[46:47], v[64:65] op_sel:[0,1] op_sel_hi:[1,1]
    v_pk_mul_f32 v[48:49], v[48:49], v[66:67] op_sel:[0,0] op_sel_hi:[1,0]
    v_pk_mul_f32 v[50:51], v[50:51], v[66:67] op_sel:[0,1] op_sel_hi:[1,1]
    v_pk_mul_f32 v[52:53], v[52:53], v[68:69] op_sel:[0,0] op_sel_hi:[1,0]
    v_pk_mul_f32 v[54:55], v[54:55], v[68:69] op_sel:[0,1] op_sel_hi:[1,1]
    v_pk_mul_f32 v[56:57], v[56:57], v[70:71] op_sel:[0,0] op_sel_hi:[1,0]
    v_pk_mul_f32 v[58:59], v[58:59], v[70:71] op_sel:[0,1] op_sel_hi:[1,1]
    v_pk_mul_f32 v[60:61], v[60:61], v[72:73] op_sel:[0,0] op_sel_hi:[1,0]
    v_pk_mul_f32 v[62:63], v[62:63], v[72:73] op_sel:[0,1] op_sel_hi:[1,1]
    v_cvt_pk_bf16_f32 v44, v44, v45
    v_cvt_pk_bf16_f32 v46, v46, v47
    v_cvt_pk_bf16_f32 v48, v48, v49
    v_cvt_pk_bf16_f32 v50, v50, v51
    v_cvt_pk_bf16_f32 v52, v52, v53
    v_cvt_pk_bf16_f32 v54, v54, v55
    v_cvt_pk_bf16_f32 v56, v56, v57
    v_cvt_pk_bf16_f32 v58, v58, v59
    v_cvt_pk_bf16_f32 v60, v60, v61
    v_cvt_pk_bf16_f32 v62, v62, v63
    s_waitcnt lgkmcnt(0)
    v_perm_b32 v4, v44, v44, v232
    v_perm_b32 v5, v44, v44, v233
    v_perm_b32 v6, v44, v44, v234
    v_perm_b32 v7, v44, v44, v235
    v_perm_b32 v8, v46, v46, v232
    v_perm_b32 v9, v46, v46, v233
    v_perm_b32 v10, v46, v46, v234
    v_perm_b32 v11, v46, v46, v235
    v_mfma_f32_16x16x32_bf16 v[132:135], v[88:91], v[4:7], 0
    v_mfma_f32_16x16x32_bf16 v[136:139], v[110:113], v[4:7], 0
    v_perm_b32 v12, v48, v48, v232
    v_perm_b32 v13, v48, v48, v233
    v_perm_b32 v14, v48, v48, v234
    v_perm_b32 v15, v48, v48, v235
    v_mfma_f32_16x16x32_bf16 v[140:143], v[90:93], v[8:11], 0
    v_mfma_f32_16x16x32_bf16 v[144:147], v[112:115], v[8:11], 0
    v_perm_b32 v16, v50, v50, v232
    v_perm_b32 v17, v50, v50, v233
    v_perm_b32 v18, v50, v50, v234
    v_perm_b32 v19, v50, v50, v235
    v_mfma_f32_16x16x32_bf16 v[148:151], v[92:95], v[12:15], 0
    v_mfma_f32_16x16x32_bf16 v[152:155], v[114:117], v[12:15], 0
    v_perm_b32 v20, v52, v52, v232
    v_perm_b32 v21, v52, v52, v233
    v_perm_b32 v22, v52, v52, v234
    v_perm_b32 v23, v52, v52, v235
    v_mfma_f32_16x16x32_bf16 v[156:159], v[94:97], v[16:19], 0
    v_mfma_f32_16x16x32_bf16 v[160:163], v[116:119], v[16:19], 0
    v_perm_b32 v24, v54, v54, v232
    v_perm_b32 v25, v54, v54, v233
    v_perm_b32 v26, v54, v54, v234
    v_perm_b32 v27, v54, v54, v235
    v_mfma_f32_16x16x32_bf16 v[164:167], v[96:99], v[20:23], 0
    v_mfma_f32_16x16x32_bf16 v[168:171], v[118:121], v[20:23], 0
    v_perm_b32 v28, v56, v56, v232
    v_perm_b32 v29, v56, v56, v233
    v_perm_b32 v30, v56, v56, v234
    v_perm_b32 v31, v56, v56, v235
    v_mfma_f32_16x16x32_bf16 v[172:175], v[98:101], v[24:27], 0
    v_mfma_f32_16x16x32_bf16 v[176:179], v[120:123], v[24:27], 0
    v_perm_b32 v32, v58, v58, v232
    v_perm_b32 v33, v58, v58, v233
    v_perm_b32 v34, v58, v58, v234
    v_perm_b32 v35, v58, v58, v235
    v_mfma_f32_16x16x32_bf16 v[180:183], v[100:103], v[28:31], 0
    v_mfma_f32_16x16x32_bf16 v[184:187], v[122:125], v[28:31], 0
    v_perm_b32 v36, v60, v60, v232
    v_perm_b32 v37, v60, v60, v233
    v_perm_b32 v38, v60, v60, v234
    v_perm_b32 v39, v60, v60, v235
    v_mfma_f32_16x16x32_bf16 v[188:191], v[102:105], v[32:35], 0
    v_mfma_f32_16x16x32_bf16 v[192:195], v[124:127], v[32:35], 0
    v_perm_b32 v40, v62, v62, v232
    v_perm_b32 v41, v62, v62, v233
    v_perm_b32 v42, v62, v62, v234
    v_perm_b32 v43, v62, v62, v235
    v_mfma_f32_16x16x32_bf16 v[196:199], v[104:107], v[36:39], 0
    v_mfma_f32_16x16x32_bf16 v[200:203], v[126:129], v[36:39], 0
    v_mfma_f32_16x16x32_bf16 v[204:207], v[106:109], v[40:43], 0
    v_mfma_f32_16x16x32_bf16 v[208:211], v[128:131], v[40:43], 0
    v_cvt_pk_bf16_f32 v44, v132, v133
    v_cvt_pk_bf16_f32 v45, v134, v135
    v_cvt_pk_bf16_f32 v46, v140, v141
    v_cvt_pk_bf16_f32 v47, v142, v143
    v_cvt_pk_bf16_f32 v48, v148, v149
    v_cvt_pk_bf16_f32 v49, v150, v151
    v_cvt_pk_bf16_f32 v50, v156, v157
    v_cvt_pk_bf16_f32 v51, v158, v159
    v_permlane16_swap_b32 v44, v46
    v_permlane16_swap_b32 v45, v47
    buffer_store_dwordx4 v[44:47], v236, s[36:39], s48 offen sc1
    v_cvt_pk_bf16_f32 v52, v164, v165
    v_cvt_pk_bf16_f32 v53, v166, v167
    v_cvt_pk_bf16_f32 v54, v172, v173
    v_cvt_pk_bf16_f32 v55, v174, v175
    v_permlane16_swap_b32 v48, v50
    v_permlane16_swap_b32 v49, v51
    buffer_store_dwordx4 v[48:51], v236, s[36:39], s49 offen sc1
    v_cvt_pk_bf16_f32 v56, v180, v181
    v_cvt_pk_bf16_f32 v57, v182, v183
    v_cvt_pk_bf16_f32 v58, v188, v189
    v_cvt_pk_bf16_f32 v59, v190, v191
    v_permlane16_swap_b32 v52, v54
    v_permlane16_swap_b32 v53, v55
    buffer_store_dwordx4 v[52:55], v236, s[36:39], s50 offen sc1
    v_cvt_pk_bf16_f32 v60, v196, v197
    v_cvt_pk_bf16_f32 v61, v198, v199
    v_cvt_pk_bf16_f32 v62, v204, v205
    v_cvt_pk_bf16_f32 v63, v206, v207
    v_permlane16_swap_b32 v56, v58
    v_permlane16_swap_b32 v57, v59
    buffer_store_dwordx4 v[56:59], v236, s[36:39], s51 offen sc1
    s_mov_b64 exec, s[28:29]
    v_cvt_pk_bf16_f32 v64, v136, v137
    v_cvt_pk_bf16_f32 v65, v138, v139
    v_cvt_pk_bf16_f32 v66, v168, v169
    v_cvt_pk_bf16_f32 v67, v170, v171
    v_cvt_pk_bf16_f32 v68, v200, v201
    v_cvt_pk_bf16_f32 v69, v202, v203
    s_mov_b64 exec, s[30:31]
    v_cvt_pk_bf16_f32 v64, v144, v145
    v_cvt_pk_bf16_f32 v65, v146, v147
    v_cvt_pk_bf16_f32 v66, v176, v177
    v_cvt_pk_bf16_f32 v67, v178, v179
    v_cvt_pk_bf16_f32 v68, v208, v209
    v_cvt_pk_bf16_f32 v69, v210, v211
    s_mov_b64 exec, s[32:33]
    v_cvt_pk_bf16_f32 v64, v152, v153
    v_cvt_pk_bf16_f32 v65, v154, v155
    v_cvt_pk_bf16_f32 v66, v184, v185
    v_cvt_pk_bf16_f32 v67, v186, v187
    s_mov_b64 exec, s[34:35]
    v_cvt_pk_bf16_f32 v64, v160, v161
    v_cvt_pk_bf16_f32 v65, v162, v163
    v_cvt_pk_bf16_f32 v66, v192, v193
    v_cvt_pk_bf16_f32 v67, v194, v195
    s_mov_b64 exec, s[24:25]
    v_permlane16_swap_b32 v60, v62
    v_permlane16_swap_b32 v61, v63
    buffer_store_dwordx4 v[60:63], v236, s[36:39], s52 offen sc1
    buffer_store_dwordx2 v[64:65], v237, s[36:39], 0 offen sc1
    buffer_store_dwordx2 v[66:67], v237, s[36:39], s58 offen sc1
    buffer_store_dwordx2 v[68:69], v244, s[36:39], s53 offen sc1
k_pub:
k_pub2:
    s_waitcnt vmcnt(0)
    s_atomic_add s13, s[10:11], s12
    s_atomic_add s15, s[10:11], s14
    s_cmp_lt_u32 s63, 2
    s_cbranch_scc1 pub_x
    s_atomic_add s17, s[10:11], s16
    s_cmp_lt_u32 s63, 3
    s_cbranch_scc1 pub_x
    s_atomic_add s19, s[10:11], s18
pub_x:
    v_mov_b32 v252, 160256
    v_mov_b32 v253, 1
    s_mov_b64 exec, 1
    ds_add_u32 v252, v253
    s_mov_b64 exec, -1
    s_waitcnt lgkmcnt(0)
k_exit:
    s_endpgm
k_end:
.section .rodata,"a"
.p2align 6
.amdhsa_kernel parallel_sum__sliding_local_dilated__glu_gated_geglu__prompt_kernel
  .amdhsa_next_free_vgpr 256
  .amdhsa_next_free_sgpr 100
  .amdhsa_accum_offset 256
  .amdhsa_group_segment_fixed_size 0
  .amdhsa_kernarg_size 80
  .amdhsa_user_sgpr_count 2
  .amdhsa_user_sgpr_kernarg_segment_ptr 1
  .amdhsa_system_sgpr_workgroup_id_x 1
.end_amdhsa_kernel
```
